```python
import torch

def _softmax(x, axis=-1):
    return torch.softmax(x, dim=axis)

def _gelu(x):
    return torch.nn.functional.gelu(x, approximate='tanh')

def _silu(x):
    return torch.nn.functional.silu(x)

def _sigmoid(x):
    return torch.sigmoid(x)

def _layernorm(x, axis=-1, eps=1e-05):
    m = x.mean(dim=axis, keepdim=True)
    v = x.var(dim=axis, keepdim=True, unbiased=False)
    return (x - m) / torch.sqrt(v + eps)

def _scatter_add(tgt, idx, src, axis=0):
    return tgt.clone().index_add_(axis, idx, src)

def _segment_sum(src, seg, n):
    out = torch.zeros((n,) + src.shape[1:], dtype=src.dtype)
    return out.index_add_(0, seg, src)

def _pad(x, pw):
    flat = tuple((v for pair in reversed(pw) for v in pair))
    return torch.nn.functional.pad(x, flat)
kernel_name = 'adaLN_cond__sliding_block_cached__dense_activation_silu__decode'

def setup_inputs():

    _w = lambda a: (lambda t: t.to(torch.bfloat16) if t.is_floating_point() else t)(torch.as_tensor(a))

    def _A_setup():
        B, Sq, D = (1, 1, 1024)
        Hq, Hkv, Sk, Dh = (32, 4, 65536, 128)
        assert Hq % Hkv == 0, (Hq, Hkv)
        return {'x': _w((lambda *s: torch.randn(*s, dtype=torch.bfloat16) * 0.1)(B, Sq, D)), 'k_cache': _w((lambda *s: torch.randn(*s, dtype=torch.bfloat16) * 0.8)(B, Hkv, Sk, Dh)), 'v_cache': _w((lambda *s: torch.randn(*s, dtype=torch.bfloat16) * 3.2)(B, Hkv, Sk, Dh)), 'wq': _w((lambda *s: torch.randn(*s, dtype=torch.bfloat16) * 0.8)(D, Hq * Dh) * D ** (-0.5)), 'wo': _w((lambda *s: torch.randn(*s, dtype=torch.bfloat16) * 3.2)(Hq * Dh, D) * (Hq * Dh) ** (-0.5))}
    _A_in = _A_setup()

    def _B_setup():
        B, S, D, F = (1, 1, 1024, 3584)
        return {'x': _w((lambda *s: torch.randn(*s, dtype=torch.bfloat16) * 0.1)(B, S, D)), 'w1': _w((lambda *s: torch.randn(*s, dtype=torch.bfloat16) * 3.2)(D, F) * D ** (-0.5)), 'w2': _w((lambda *s: torch.randn(*s, dtype=torch.bfloat16) * 3.2)(F, D) * F ** (-0.5))}
    _B_in = _B_setup()
    return {'A_x': _A_in['x'], 'A_k_cache': _A_in['k_cache'], 'A_v_cache': _A_in['v_cache'], 'A_wq': _A_in['wq'], 'A_wo': _A_in['wo'], 'B_x': _B_in['x'], 'B_w1': _B_in['w1'], 'B_w2': _B_in['w2'], 'c': _w((lambda *s: torch.randn(*s, dtype=torch.bfloat16) * 0.4)(1, 1024) * 8.0), 'w_mod': _w((lambda *s: torch.randn(*s, dtype=torch.bfloat16) * 0.4)(1024, 6 * 1024) * 1024 ** (-0.5) * 8.0)}

def reference(A_x, A_k_cache, A_v_cache, A_wq, A_wo, B_x, B_w1, B_w2, c, w_mod):

    def _A_ref(x, k_cache, v_cache, wq, wo):
        B, Sq, D = x.shape
        Hq, Dh = (32, 128)
        Hkv, Sk = (k_cache.shape[1], k_cache.shape[2])
        W = min(4096, max(256, Sk // 4))
        rep = Hq // Hkv
        q = (lambda x, *d: x.permute(*d))((x @ wq).reshape(B, Sq, Hq, Dh), 0, 2, 1, 3)
        k = (lambda x, n, axis: torch.repeat_interleave(x, n, dim=axis))(k_cache[:, :, Sk - W:, :], rep, axis=1)
        v = (lambda x, n, axis: torch.repeat_interleave(x, n, dim=axis))(v_cache[:, :, Sk - W:, :], rep, axis=1)
        scores = torch.einsum('bhqd,bhkd->bhqk', q, k) * Dh ** (-0.5)
        p = _softmax(scores, axis=-1)
        o = torch.einsum('bhqk,bhkd->bhqd', p, v)
        return (lambda x, *d: x.permute(*d))(o, 0, 2, 1, 3).reshape(B, Sq, Hq * Dh) @ wo

    def _B_ref(x, w1, w2):
        h = torch.einsum('bsd,df->bsf', x, w1)
        h = _silu(h)
        out = torch.einsum('bsf,fd->bsd', h, w2)
        return out
    x = A_x
    mod = (_silu(c) @ w_mod).reshape(c.shape[0], 6, 1, -1)
    sa, ca, ga, sb, cb, gb = (mod[:, 0].clone(), mod[:, 1].clone(), mod[:, 2].clone(), mod[:, 3].clone(), mod[:, 4].clone(), mod[:, 5].clone())
    h = _layernorm(x, axis=-1) * (1 + ca) + sa
    x = x + ga * _A_ref(h, A_k_cache, A_v_cache, A_wq, A_wo)
    h = _layernorm(x, axis=-1) * (1 + cb) + sb
    x = x + gb * _B_ref(h, B_w1, B_w2)
    return x
```

```asm
; @launch grid=(256,1,1) block=(512,1,1) lds=49152
.amdgcn_target "amdgcn-amd-amdhsa--gfx950"
.text
.globl adaLN_cond__sliding_block_cached__dense_activation_silu__decode_kernel
.p2align 10
.p2align 8
.type adaLN_cond__sliding_block_cached__dense_activation_silu__decode_kernel,@function
adaLN_cond__sliding_block_cached__dense_activation_silu__decode_kernel:
s_cmp_ge_u32 s2, 256
s_cbranch_scc1 L_end
s_load_dwordx16 s[4:19], s[0:1], 0
s_load_dwordx8 s[20:27], s[0:1], 64
s_load_dwordx2 s[28:29], s[0:1], 96
v_lshrrev_b32 v2, 6, v0
v_and_b32 v1, 63, v0
v_readfirstlane_b32 s3, v2
s_bfe_u32 s48, s2, 0x20001
s_lshr_b32 s49, s2, 3
v_and_b32 v2, 15, v1
v_lshrrev_b32 v3, 4, v1
v_lshlrev_b32 v2, 4, v2
s_cmp_lg_u32 s3, 5
s_cbranch_scc1 sk_1
s_getpc_b64 s[32:33]
L_pc:
s_bitcmp1_b32 s2, 0
s_mov_b32 s51, L_pclass-L_pc
s_cselect_b32 s50, L_rclass-L_pc, s51
s_lshl_b32 s51, s49, 9
s_add_u32 s50, s50, s51
s_min_u32 s50, s50, L_end-L_pc-452
s_add_u32 s32, s32, s50
s_addc_u32 s33, s33, 0
s_load_dword s34, s[32:33], 0
s_load_dword s35, s[32:33], 64
s_load_dword s34, s[32:33], 128
s_load_dword s35, s[32:33], 192
s_load_dword s34, s[32:33], 256
s_load_dword s35, s[32:33], 320
s_load_dword s34, s[32:33], 384
s_load_dword s35, s[32:33], 448
sk_1:
s_bitcmp1_b32 s2, 0
s_cbranch_scc0 L_pfront
s_mov_b32 s50, 98304
v_mul_lo_u32 v13, v3, s50
v_add_u32 v13, v13, v2
s_lshr_b32 s59, s49, 2
s_lshl_b32 s59, s59, 2
s_and_b32 s50, s3, 3
s_add_u32 s59, s59, s50
s_mul_i32 s58, s59, 393216
s_bfe_u32 s51, s49, 0x10001
s_lshl_b32 s51, s51, 3
s_lshl_b32 s50, s48, 1
s_add_u32 s51, s51, s50
s_and_b32 s50, s49, 1
s_add_u32 s51, s51, s50
s_lshl_b32 s50, s51, 8
s_add_u32 s58, s58, s50
s_cmp_ge_u32 s3, 4
s_cbranch_scc1 L_r_hi
s_lshl_b32 s59, s59, 6
s_waitcnt lgkmcnt(0)
s_mov_b32 s36, s22
s_mov_b32 s37, s23
s_mov_b32 s38, 0xc00000
s_mov_b32 s39, 0x20000
buffer_load_dwordx4 v[64:67], v13, s[36:39], s58 offen nt
s_add_u32 s50, s58, 0x3000
buffer_load_dwordx4 v[68:71], v13, s[36:39], s50 offen nt
s_add_u32 s50, s58, 0x6000
buffer_load_dwordx4 v[72:75], v13, s[36:39], s50 offen nt
s_add_u32 s50, s58, 0x9000
buffer_load_dwordx4 v[76:79], v13, s[36:39], s50 offen nt
s_add_u32 s50, s58, 0xc000
buffer_load_dwordx4 v[80:83], v13, s[36:39], s50 offen nt
s_add_u32 s50, s58, 0xf000
buffer_load_dwordx4 v[84:87], v13, s[36:39], s50 offen nt
s_add_u32 s50, s58, 0x12000
buffer_load_dwordx4 v[88:91], v13, s[36:39], s50 offen nt
s_add_u32 s50, s58, 0x15000
buffer_load_dwordx4 v[92:95], v13, s[36:39], s50 offen nt
s_branch L_r_m2
L_pfront:
s_cmp_ge_u32 s3, 4
s_cbranch_scc1 L_p_a
s_mov_b32 s50, 65536
v_mul_lo_u32 v12, v3, s50
v_add_u32 v12, v12, v2
s_lshr_b32 s62, s49, 3
s_and_b32 s57, s49, 7
s_xor_b32 s57, s57, s3
s_lshl_b32 s50, s62, 3
s_add_u32 s57, s57, s50
s_lshl_b32 s60, s57, 18
s_lshl_b32 s61, s48, 3
s_and_b32 s50, s49, 7
s_add_u32 s61, s61, s50
s_lshl_b32 s50, s61, 8
s_add_u32 s60, s60, s50
v_lshlrev_b32 v15, 5, v1
v_lshrrev_b32 v22, 5, v1
v_lshlrev_b32 v22, 2, v22
v_xor_b32 v22, s57, v22
v_and_b32 v21, 31, v1
v_lshl_add_u32 v22, v22, 5, v21
v_lshlrev_b32 v21, 1, v22
v_lshlrev_b32 v22, 3, v22
s_waitcnt lgkmcnt(0)
s_mov_b32 s32, s10
s_mov_b32 s33, s11
s_mov_b32 s34, 0x800000
s_mov_b32 s35, 0x20000
buffer_load_dwordx4 v[64:67], v12, s[32:35], s60 offen nt
s_add_u32 s50, s60, 0x2000
buffer_load_dwordx4 v[68:71], v12, s[32:35], s50 offen nt
s_add_u32 s50, s60, 0x4000
buffer_load_dwordx4 v[72:75], v12, s[32:35], s50 offen nt
s_add_u32 s50, s60, 0x6000
buffer_load_dwordx4 v[76:79], v12, s[32:35], s50 offen nt
s_add_u32 s50, s60, 0x8000
buffer_load_dwordx4 v[80:83], v12, s[32:35], s50 offen nt
s_add_u32 s50, s60, 0xa000
buffer_load_dwordx4 v[84:87], v12, s[32:35], s50 offen nt
s_add_u32 s50, s60, 0xc000
buffer_load_dwordx4 v[88:91], v12, s[32:35], s50 offen nt
s_add_u32 s50, s60, 0xe000
buffer_load_dwordx4 v[92:95], v12, s[32:35], s50 offen nt
s_load_dword s30, s[28:29], 0
s_mov_b32 s44, s4
s_mov_b32 s45, s5
s_mov_b32 s46, 0x800
s_mov_b32 s47, 0x20000
buffer_load_dwordx4 v[192:195], v15, s[44:47], 0 offen
buffer_load_dwordx4 v[196:199], v15, s[44:47], 0 offen offset:16
buffer_load_ushort v24, v21, s[44:47], 0 offen
s_xor_b32 s60, s60, 0x100000
buffer_load_dwordx4 v[96:99], v12, s[32:35], s60 offen nt
s_add_u32 s50, s60, 0x2000
buffer_load_dwordx4 v[100:103], v12, s[32:35], s50 offen nt
s_add_u32 s50, s60, 0x4000
buffer_load_dwordx4 v[104:107], v12, s[32:35], s50 offen nt
s_add_u32 s50, s60, 0x6000
buffer_load_dwordx4 v[108:111], v12, s[32:35], s50 offen nt
s_add_u32 s50, s60, 0x8000
buffer_load_dwordx4 v[112:115], v12, s[32:35], s50 offen nt
s_add_u32 s50, s60, 0xa000
buffer_load_dwordx4 v[116:119], v12, s[32:35], s50 offen nt
s_add_u32 s50, s60, 0xc000
buffer_load_dwordx4 v[120:123], v12, s[32:35], s50 offen nt
s_add_u32 s50, s60, 0xe000
buffer_load_dwordx4 v[124:127], v12, s[32:35], s50 offen nt
s_branch L_p_h2
L_rclass:
L_r_m2:
s_load_dwordx16 s[4:19], s[20:21], s59
s_load_dword s30, s[28:29], 0
s_getreg_b32 s66, hwreg(HW_REG_XCC_ID, 0, 4)
s_mov_b32 s67, 0x05040100
s_mov_b32 s68, 0x07060302
s_mov_b32 s69, 0xfffffff0
s_mov_b32 s65, 0
v_lshlrev_b32 v4, 4, v3
v_lshlrev_b32 v5, 1, v2
v_lshl_add_u32 v5, v3, 3, v5
s_lshl_b32 s50, s3, 9
s_add_u32 s50, s50, 0x400
v_add_u32 v8, s50, v5
v_lshlrev_b32 v9, 2, v1
s_and_b32 s50, s3, 1
s_lshl_b32 s50, s50, 8
v_add_u32 v6, s50, v9
s_lshl_b32 s50, s3, 6
s_add_u32 s50, s50, 0x200
v_add_u32 v7, s50, v4
v_lshlrev_b32 v10, 3, v1
s_mov_b32 s40, s28
s_mov_b32 s41, s29
s_mov_b32 s42, 0x10000000
s_mov_b32 s43, 0x20000
s_waitcnt lgkmcnt(0)
s_mov_b32 exec_lo, 0xffff
s_mov_b32 exec_hi, 0x0
v_mov_b32 v16, s4
v_mov_b32 v17, s5
v_mov_b32 v18, s6
v_mov_b32 v19, s7
s_mov_b32 exec_lo, 0xffff0000
s_mov_b32 exec_hi, 0x0
v_mov_b32 v16, s8
v_mov_b32 v17, s9
v_mov_b32 v18, s10
v_mov_b32 v19, s11
s_mov_b32 exec_lo, 0x0
s_mov_b32 exec_hi, 0xffff
v_mov_b32 v16, s12
v_mov_b32 v17, s13
v_mov_b32 v18, s14
v_mov_b32 v19, s15
s_mov_b32 exec_lo, 0x0
s_mov_b32 exec_hi, 0xffff0000
v_mov_b32 v16, s16
v_mov_b32 v17, s17
v_mov_b32 v18, s18
v_mov_b32 v19, s19
s_mov_b64 exec, -1
s_load_dwordx16 s[4:19], s[0:1], 0
v_lshlrev_b32 v160, 16, v16
v_and_b32 v161, 0xffff0000, v16
v_lshlrev_b32 v162, 16, v17
v_and_b32 v163, 0xffff0000, v17
v_mul_f32 v164, 0xbfb8aa3b, v160
v_mul_f32 v165, 0xbfb8aa3b, v161
v_mul_f32 v166, 0xbfb8aa3b, v162
v_mul_f32 v167, 0xbfb8aa3b, v163
v_exp_f32 v164, v164
v_exp_f32 v165, v165
v_exp_f32 v166, v166
v_exp_f32 v167, v167
v_add_f32 v164, 1.0, v164
v_add_f32 v165, 1.0, v165
v_add_f32 v166, 1.0, v166
v_add_f32 v167, 1.0, v167
v_min_f32 v164, 0x7f000000, v164
v_min_f32 v165, 0x7f000000, v165
v_min_f32 v166, 0x7f000000, v166
v_min_f32 v167, 0x7f000000, v167
v_rcp_f32 v168, v164
v_rcp_f32 v169, v165
v_rcp_f32 v170, v166
v_rcp_f32 v171, v167
v_mul_f32 v172, v160, v168
v_mul_f32 v173, v161, v169
v_mul_f32 v174, v162, v170
v_mul_f32 v175, v163, v171
v_fma_f32 v160, -v172, v164, v160
v_fma_f32 v161, -v173, v165, v161
v_fma_f32 v162, -v174, v166, v162
v_fma_f32 v163, -v175, v167, v163
v_fma_f32 v160, v160, v168, v172
v_fma_f32 v161, v161, v169, v173
v_fma_f32 v162, v162, v170, v174
v_fma_f32 v163, v163, v171, v175
v_cvt_pk_bf16_f32 v16, v160, v161
v_cvt_pk_bf16_f32 v17, v162, v163
v_lshlrev_b32 v160, 16, v18
v_and_b32 v161, 0xffff0000, v18
v_lshlrev_b32 v162, 16, v19
v_and_b32 v163, 0xffff0000, v19
v_mul_f32 v164, 0xbfb8aa3b, v160
v_mul_f32 v165, 0xbfb8aa3b, v161
v_mul_f32 v166, 0xbfb8aa3b, v162
v_mul_f32 v167, 0xbfb8aa3b, v163
v_exp_f32 v164, v164
v_exp_f32 v165, v165
v_exp_f32 v166, v166
v_exp_f32 v167, v167
v_add_f32 v164, 1.0, v164
v_add_f32 v165, 1.0, v165
v_add_f32 v166, 1.0, v166
v_add_f32 v167, 1.0, v167
v_min_f32 v164, 0x7f000000, v164
v_min_f32 v165, 0x7f000000, v165
v_min_f32 v166, 0x7f000000, v166
v_min_f32 v167, 0x7f000000, v167
v_rcp_f32 v168, v164
v_rcp_f32 v169, v165
v_rcp_f32 v170, v166
v_rcp_f32 v171, v167
v_mul_f32 v172, v160, v168
v_mul_f32 v173, v161, v169
v_mul_f32 v174, v162, v170
v_mul_f32 v175, v163, v171
v_fma_f32 v160, -v172, v164, v160
v_fma_f32 v161, -v173, v165, v161
v_fma_f32 v162, -v174, v166, v162
v_fma_f32 v163, -v175, v167, v163
v_fma_f32 v160, v160, v168, v172
v_fma_f32 v161, v161, v169, v173
v_fma_f32 v162, v162, v170, v174
v_fma_f32 v163, v163, v171, v175
v_cvt_pk_bf16_f32 v18, v160, v161
v_cvt_pk_bf16_f32 v19, v162, v163
s_waitcnt vmcnt(6)
v_perm_b32 v128, v68, v64, s67
v_perm_b32 v132, v68, v64, s68
v_perm_b32 v136, v69, v65, s67
v_perm_b32 v140, v69, v65, s68
v_perm_b32 v144, v70, v66, s67
v_perm_b32 v148, v70, v66, s68
v_perm_b32 v152, v71, v67, s67
v_perm_b32 v156, v71, v67, s68
s_waitcnt vmcnt(4)
v_perm_b32 v129, v76, v72, s67
v_perm_b32 v133, v76, v72, s68
v_perm_b32 v137, v77, v73, s67
v_perm_b32 v141, v77, v73, s68
v_perm_b32 v145, v78, v74, s67
v_perm_b32 v149, v78, v74, s68
v_perm_b32 v153, v79, v75, s67
v_perm_b32 v157, v79, v75, s68
s_waitcnt vmcnt(2)
v_perm_b32 v130, v84, v80, s67
v_perm_b32 v134, v84, v80, s68
v_perm_b32 v138, v85, v81, s67
v_perm_b32 v142, v85, v81, s68
v_perm_b32 v146, v86, v82, s67
v_perm_b32 v150, v86, v82, s68
v_perm_b32 v154, v87, v83, s67
v_perm_b32 v158, v87, v83, s68
s_waitcnt vmcnt(0)
v_perm_b32 v131, v92, v88, s67
v_perm_b32 v135, v92, v88, s68
v_perm_b32 v139, v93, v89, s67
v_perm_b32 v143, v93, v89, s68
v_perm_b32 v147, v94, v90, s67
v_perm_b32 v151, v94, v90, s68
v_perm_b32 v155, v95, v91, s67
v_perm_b32 v159, v95, v91, s68
v_mfma_f32_16x16x32_bf16 v[32:35], v[16:19], v[128:131], 0
v_mfma_f32_16x16x32_bf16 v[36:39], v[16:19], v[132:135], 0
v_mfma_f32_16x16x32_bf16 v[40:43], v[16:19], v[136:139], 0
v_mfma_f32_16x16x32_bf16 v[44:47], v[16:19], v[140:143], 0
v_mfma_f32_16x16x32_bf16 v[48:51], v[16:19], v[144:147], 0
v_mfma_f32_16x16x32_bf16 v[52:55], v[16:19], v[148:151], 0
v_mfma_f32_16x16x32_bf16 v[56:59], v[16:19], v[152:155], 0
v_mfma_f32_16x16x32_bf16 v[60:63], v[16:19], v[156:159], 0
s_nop 0
v_mov_b32_dpp v28, v32 quad_perm:[0,1,2,3] row_mask:0x1 bank_mask:0xf
v_mov_b32_dpp v29, v36 quad_perm:[0,1,2,3] row_mask:0x1 bank_mask:0xf
v_mov_b32_dpp v28, v40 quad_perm:[0,1,2,3] row_mask:0x2 bank_mask:0xf
v_mov_b32_dpp v29, v44 quad_perm:[0,1,2,3] row_mask:0x2 bank_mask:0xf
v_mov_b32_dpp v28, v48 quad_perm:[0,1,2,3] row_mask:0x4 bank_mask:0xf
v_mov_b32_dpp v29, v52 quad_perm:[0,1,2,3] row_mask:0x4 bank_mask:0xf
v_mov_b32_dpp v28, v56 quad_perm:[0,1,2,3] row_mask:0x8 bank_mask:0xf
v_mov_b32_dpp v29, v60 quad_perm:[0,1,2,3] row_mask:0x8 bank_mask:0xf
ds_write_b64 v8, v[28:29]
s_waitcnt lgkmcnt(0)
s_barrier
s_waitcnt lgkmcnt(0)
s_add_u32 s31, s30, 0x9e3779b9
s_mul_i32 s31, s31, 0x85ebca6b
s_lshr_b32 s50, s31, 15
s_xor_b32 s31, s31, s50
s_mul_i32 s31, s31, 0xc2b2ae35
s_lshr_b32 s50, s31, 13
s_xor_b32 s31, s31, s50
s_or_b32 s31, s31, 0x11111111
s_xor_b32 s31, s31, s30
v_and_b32 v11, 7, v1
v_lshlrev_b32 v11, 2, v11
v_bfe_u32 v11, s31, v11, 4
v_and_b32 v251, 1, v1
v_lshlrev_b32 v251, 4, v251
v_lshrrev_b32 v251, v251, s31
v_bfe_u32 v248, v251, 0, 4
v_bfe_u32 v249, v251, 4, 4
v_bfe_u32 v250, v251, 8, 4
v_bfe_u32 v251, v251, 12, 4
v_and_b32 v253, 3, v1
v_lshlrev_b32 v253, 3, v253
v_lshrrev_b32 v253, v253, s31
v_bfe_u32 v252, v253, 0, 4
v_bfe_u32 v253, v253, 4, 4
s_lshl_b32 s63, s48, 2
s_add_u32 s63, s63, s49
s_sub_u32 s63, s63, 28
s_and_b32 s63, s63, 15
v_lshrrev_b32 v22, 2, v2
v_add_u32 v22, v22, v3
v_lshlrev_b32 v23, 1, v22
v_lshlrev_b32 v25, 3, v22
v_lshlrev_b32 v22, 2, v22
v_lshl_add_u32 v14, v3, 9, v2
v_and_b32 v15, 1, v3
v_lshl_add_u32 v15, v15, 9, v2
s_mov_b32 s60, s49
s_cmp_eq_u32 s3, 3
s_cselect_b32 s61, 0x9dddddd, 0
s_cmp_eq_u32 s3, 2
s_cselect_b32 s61, 0x9115555, s61
s_cmp_lg_u32 s3, 2
s_cbranch_scc1 sk_2
s_lshr_b32 s50, s49, 2
s_add_u32 s50, s50, 28
s_xor_b32 s49, s49, 1
s_and_b32 s52, s60, 3
s_cmp_eq_u32 s52, 2
s_cselect_b32 s49, s50, s49
sk_2:
s_lshr_b32 s53, s49, 1
s_lshl_b32 s55, s48, 1
s_and_b32 s50, s49, 1
s_add_u32 s55, s55, s50
s_xor_b32 s55, s55, 1
s_mul_i32 s54, s53, 786432
s_lshl_b32 s50, s55, 8
s_add_u32 s54, s54, s50
s_add_u32 s54, s54, 4096
s_lshl_b32 s56, s55, 4
s_add_u32 s56, s56, s53
s_lshl_b32 s56, s56, 9
s_add_u32 s56, s56, 0x80000
s_barrier
s_bitcmp1_b32 s61, s60
s_cbranch_scc1 sk_3
s_mov_b32 s49, s60
s_branch L_r_join
sk_3:
buffer_load_dwordx4 v[96:99], v13, s[36:39], s54 offen nt
s_add_u32 s50, s54, 0x3000
buffer_load_dwordx4 v[100:103], v13, s[36:39], s50 offen nt
s_add_u32 s50, s54, 0x6000
buffer_load_dwordx4 v[104:107], v13, s[36:39], s50 offen nt
s_add_u32 s50, s54, 0x9000
buffer_load_dwordx4 v[108:111], v13, s[36:39], s50 offen nt
s_add_u32 s50, s54, 0xc000
buffer_load_dwordx4 v[112:115], v13, s[36:39], s50 offen nt
s_add_u32 s50, s54, 0xf000
buffer_load_dwordx4 v[116:119], v13, s[36:39], s50 offen nt
s_add_u32 s50, s54, 0x12000
buffer_load_dwordx4 v[120:123], v13, s[36:39], s50 offen nt
s_add_u32 s50, s54, 0x15000
buffer_load_dwordx4 v[124:127], v13, s[36:39], s50 offen nt
s_add_u32 s50, s54, 0x60000
buffer_load_dwordx4 v[160:163], v13, s[36:39], s50 offen nt
s_add_u32 s50, s54, 0x63000
buffer_load_dwordx4 v[164:167], v13, s[36:39], s50 offen nt
s_add_u32 s50, s54, 0x66000
buffer_load_dwordx4 v[168:171], v13, s[36:39], s50 offen nt
s_add_u32 s50, s54, 0x69000
buffer_load_dwordx4 v[172:175], v13, s[36:39], s50 offen nt
s_add_u32 s50, s54, 0x6c000
buffer_load_dwordx4 v[176:179], v13, s[36:39], s50 offen nt
s_add_u32 s50, s54, 0x6f000
buffer_load_dwordx4 v[180:183], v13, s[36:39], s50 offen nt
s_add_u32 s50, s54, 0x72000
buffer_load_dwordx4 v[184:187], v13, s[36:39], s50 offen nt
s_add_u32 s50, s54, 0x75000
buffer_load_dwordx4 v[188:191], v13, s[36:39], s50 offen nt
s_barrier
s_lshr_b32 s50, s49, 1
s_lshl_b32 s50, s50, 7
s_load_dwordx16 s[4:19], s[20:21], s50
s_waitcnt lgkmcnt(0)
s_mov_b32 exec_lo, 0xffff
s_mov_b32 exec_hi, 0x0
v_mov_b32 v224, s4
v_mov_b32 v225, s5
v_mov_b32 v226, s6
v_mov_b32 v227, s7
s_mov_b32 exec_lo, 0xffff0000
s_mov_b32 exec_hi, 0x0
v_mov_b32 v224, s8
v_mov_b32 v225, s9
v_mov_b32 v226, s10
v_mov_b32 v227, s11
s_mov_b32 exec_lo, 0x0
s_mov_b32 exec_hi, 0xffff
v_mov_b32 v224, s12
v_mov_b32 v225, s13
v_mov_b32 v226, s14
v_mov_b32 v227, s15
s_mov_b32 exec_lo, 0x0
s_mov_b32 exec_hi, 0xffff0000
v_mov_b32 v224, s16
v_mov_b32 v225, s17
v_mov_b32 v226, s18
v_mov_b32 v227, s19
s_mov_b64 exec, -1
s_add_u32 s50, s50, 64
s_load_dwordx16 s[4:19], s[20:21], s50
s_waitcnt lgkmcnt(0)
s_mov_b32 exec_lo, 0xffff
s_mov_b32 exec_hi, 0x0
v_mov_b32 v228, s4
v_mov_b32 v229, s5
v_mov_b32 v230, s6
v_mov_b32 v231, s7
s_mov_b32 exec_lo, 0xffff0000
s_mov_b32 exec_hi, 0x0
v_mov_b32 v228, s8
v_mov_b32 v229, s9
v_mov_b32 v230, s10
v_mov_b32 v231, s11
s_mov_b32 exec_lo, 0x0
s_mov_b32 exec_hi, 0xffff
v_mov_b32 v228, s12
v_mov_b32 v229, s13
v_mov_b32 v230, s14
v_mov_b32 v231, s15
s_mov_b32 exec_lo, 0x0
s_mov_b32 exec_hi, 0xffff0000
v_mov_b32 v228, s16
v_mov_b32 v229, s17
v_mov_b32 v230, s18
v_mov_b32 v231, s19
s_mov_b64 exec, -1
s_load_dwordx16 s[4:19], s[0:1], 0
v_lshlrev_b32 v32, 16, v224
v_and_b32 v33, 0xffff0000, v224
v_lshlrev_b32 v34, 16, v225
v_and_b32 v35, 0xffff0000, v225
v_mul_f32 v36, 0xbfb8aa3b, v32
v_mul_f32 v37, 0xbfb8aa3b, v33
v_mul_f32 v38, 0xbfb8aa3b, v34
v_mul_f32 v39, 0xbfb8aa3b, v35
v_exp_f32 v36, v36
v_exp_f32 v37, v37
v_exp_f32 v38, v38
v_exp_f32 v39, v39
v_add_f32 v36, 1.0, v36
v_add_f32 v37, 1.0, v37
v_add_f32 v38, 1.0, v38
v_add_f32 v39, 1.0, v39
v_min_f32 v36, 0x7f000000, v36
v_min_f32 v37, 0x7f000000, v37
v_min_f32 v38, 0x7f000000, v38
v_min_f32 v39, 0x7f000000, v39
v_rcp_f32 v40, v36
v_rcp_f32 v41, v37
v_rcp_f32 v42, v38
v_rcp_f32 v43, v39
v_mul_f32 v44, v32, v40
v_mul_f32 v45, v33, v41
v_mul_f32 v46, v34, v42
v_mul_f32 v47, v35, v43
v_fma_f32 v32, -v44, v36, v32
v_fma_f32 v33, -v45, v37, v33
v_fma_f32 v34, -v46, v38, v34
v_fma_f32 v35, -v47, v39, v35
v_fma_f32 v32, v32, v40, v44
v_fma_f32 v33, v33, v41, v45
v_fma_f32 v34, v34, v42, v46
v_fma_f32 v35, v35, v43, v47
v_cvt_pk_bf16_f32 v224, v32, v33
v_cvt_pk_bf16_f32 v225, v34, v35
v_lshlrev_b32 v32, 16, v226
v_and_b32 v33, 0xffff0000, v226
v_lshlrev_b32 v34, 16, v227
v_and_b32 v35, 0xffff0000, v227
v_mul_f32 v36, 0xbfb8aa3b, v32
v_mul_f32 v37, 0xbfb8aa3b, v33
v_mul_f32 v38, 0xbfb8aa3b, v34
v_mul_f32 v39, 0xbfb8aa3b, v35
v_exp_f32 v36, v36
v_exp_f32 v37, v37
v_exp_f32 v38, v38
v_exp_f32 v39, v39
v_add_f32 v36, 1.0, v36
v_add_f32 v37, 1.0, v37
v_add_f32 v38, 1.0, v38
v_add_f32 v39, 1.0, v39
v_min_f32 v36, 0x7f000000, v36
v_min_f32 v37, 0x7f000000, v37
v_min_f32 v38, 0x7f000000, v38
v_min_f32 v39, 0x7f000000, v39
v_rcp_f32 v40, v36
v_rcp_f32 v41, v37
v_rcp_f32 v42, v38
v_rcp_f32 v43, v39
v_mul_f32 v44, v32, v40
v_mul_f32 v45, v33, v41
v_mul_f32 v46, v34, v42
v_mul_f32 v47, v35, v43
v_fma_f32 v32, -v44, v36, v32
v_fma_f32 v33, -v45, v37, v33
v_fma_f32 v34, -v46, v38, v34
v_fma_f32 v35, -v47, v39, v35
v_fma_f32 v32, v32, v40, v44
v_fma_f32 v33, v33, v41, v45
v_fma_f32 v34, v34, v42, v46
v_fma_f32 v35, v35, v43, v47
v_cvt_pk_bf16_f32 v226, v32, v33
v_cvt_pk_bf16_f32 v227, v34, v35
v_lshlrev_b32 v32, 16, v228
v_and_b32 v33, 0xffff0000, v228
v_lshlrev_b32 v34, 16, v229
v_and_b32 v35, 0xffff0000, v229
v_mul_f32 v36, 0xbfb8aa3b, v32
v_mul_f32 v37, 0xbfb8aa3b, v33
v_mul_f32 v38, 0xbfb8aa3b, v34
v_mul_f32 v39, 0xbfb8aa3b, v35
v_exp_f32 v36, v36
v_exp_f32 v37, v37
v_exp_f32 v38, v38
v_exp_f32 v39, v39
v_add_f32 v36, 1.0, v36
v_add_f32 v37, 1.0, v37
v_add_f32 v38, 1.0, v38
v_add_f32 v39, 1.0, v39
v_min_f32 v36, 0x7f000000, v36
v_min_f32 v37, 0x7f000000, v37
v_min_f32 v38, 0x7f000000, v38
v_min_f32 v39, 0x7f000000, v39
v_rcp_f32 v40, v36
v_rcp_f32 v41, v37
v_rcp_f32 v42, v38
v_rcp_f32 v43, v39
v_mul_f32 v44, v32, v40
v_mul_f32 v45, v33, v41
v_mul_f32 v46, v34, v42
v_mul_f32 v47, v35, v43
v_fma_f32 v32, -v44, v36, v32
v_fma_f32 v33, -v45, v37, v33
v_fma_f32 v34, -v46, v38, v34
v_fma_f32 v35, -v47, v39, v35
v_fma_f32 v32, v32, v40, v44
v_fma_f32 v33, v33, v41, v45
v_fma_f32 v34, v34, v42, v46
v_fma_f32 v35, v35, v43, v47
v_cvt_pk_bf16_f32 v228, v32, v33
v_cvt_pk_bf16_f32 v229, v34, v35
v_lshlrev_b32 v32, 16, v230
v_and_b32 v33, 0xffff0000, v230
v_lshlrev_b32 v34, 16, v231
v_and_b32 v35, 0xffff0000, v231
v_mul_f32 v36, 0xbfb8aa3b, v32
v_mul_f32 v37, 0xbfb8aa3b, v33
v_mul_f32 v38, 0xbfb8aa3b, v34
v_mul_f32 v39, 0xbfb8aa3b, v35
v_exp_f32 v36, v36
v_exp_f32 v37, v37
v_exp_f32 v38, v38
v_exp_f32 v39, v39
v_add_f32 v36, 1.0, v36
v_add_f32 v37, 1.0, v37
v_add_f32 v38, 1.0, v38
v_add_f32 v39, 1.0, v39
v_min_f32 v36, 0x7f000000, v36
v_min_f32 v37, 0x7f000000, v37
v_min_f32 v38, 0x7f000000, v38
v_min_f32 v39, 0x7f000000, v39
v_rcp_f32 v40, v36
v_rcp_f32 v41, v37
v_rcp_f32 v42, v38
v_rcp_f32 v43, v39
v_mul_f32 v44, v32, v40
v_mul_f32 v45, v33, v41
v_mul_f32 v46, v34, v42
v_mul_f32 v47, v35, v43
v_fma_f32 v32, -v44, v36, v32
v_fma_f32 v33, -v45, v37, v33
v_fma_f32 v34, -v46, v38, v34
v_fma_f32 v35, -v47, v39, v35
v_fma_f32 v32, v32, v40, v44
v_fma_f32 v33, v33, v41, v45
v_fma_f32 v34, v34, v42, v46
v_fma_f32 v35, v35, v43, v47
v_cvt_pk_bf16_f32 v230, v32, v33
v_cvt_pk_bf16_f32 v231, v34, v35
s_waitcnt lgkmcnt(0)
s_mov_b32 s49, s60
s_waitcnt vmcnt(8)
v_perm_b32 v192, v100, v96, s67
v_perm_b32 v196, v100, v96, s68
v_perm_b32 v200, v101, v97, s67
v_perm_b32 v204, v101, v97, s68
v_perm_b32 v208, v102, v98, s67
v_perm_b32 v212, v102, v98, s68
v_perm_b32 v216, v103, v99, s67
v_perm_b32 v220, v103, v99, s68
v_perm_b32 v193, v108, v104, s67
v_perm_b32 v197, v108, v104, s68
v_perm_b32 v201, v109, v105, s67
v_perm_b32 v205, v109, v105, s68
v_perm_b32 v209, v110, v106, s67
v_perm_b32 v213, v110, v106, s68
v_perm_b32 v217, v111, v107, s67
v_perm_b32 v221, v111, v107, s68
v_perm_b32 v194, v116, v112, s67
v_perm_b32 v198, v116, v112, s68
v_perm_b32 v202, v117, v113, s67
v_perm_b32 v206, v117, v113, s68
v_perm_b32 v210, v118, v114, s67
v_perm_b32 v214, v118, v114, s68
v_perm_b32 v218, v119, v115, s67
v_perm_b32 v222, v119, v115, s68
v_perm_b32 v195, v124, v120, s67
v_perm_b32 v199, v124, v120, s68
v_perm_b32 v203, v125, v121, s67
v_perm_b32 v207, v125, v121, s68
v_perm_b32 v211, v126, v122, s67
v_perm_b32 v215, v126, v122, s68
v_perm_b32 v219, v127, v123, s67
v_perm_b32 v223, v127, v123, s68
v_mfma_f32_16x16x32_bf16 v[32:35], v[224:227], v[192:195], 0
v_mfma_f32_16x16x32_bf16 v[36:39], v[224:227], v[196:199], 0
v_mfma_f32_16x16x32_bf16 v[40:43], v[224:227], v[200:203], 0
v_mfma_f32_16x16x32_bf16 v[44:47], v[224:227], v[204:207], 0
v_mfma_f32_16x16x32_bf16 v[48:51], v[224:227], v[208:211], 0
v_mfma_f32_16x16x32_bf16 v[52:55], v[224:227], v[212:215], 0
v_mfma_f32_16x16x32_bf16 v[56:59], v[224:227], v[216:219], 0
v_mfma_f32_16x16x32_bf16 v[60:63], v[224:227], v[220:223], 0
s_waitcnt vmcnt(0)
v_perm_b32 v96, v164, v160, s67
v_perm_b32 v100, v164, v160, s68
v_perm_b32 v104, v165, v161, s67
v_perm_b32 v108, v165, v161, s68
v_perm_b32 v112, v166, v162, s67
v_perm_b32 v116, v166, v162, s68
v_perm_b32 v120, v167, v163, s67
v_perm_b32 v124, v167, v163, s68
v_perm_b32 v97, v172, v168, s67
v_perm_b32 v101, v172, v168, s68
v_perm_b32 v105, v173, v169, s67
v_perm_b32 v109, v173, v169, s68
v_perm_b32 v113, v174, v170, s67
v_perm_b32 v117, v174, v170, s68
v_perm_b32 v121, v175, v171, s67
v_perm_b32 v125, v175, v171, s68
v_perm_b32 v98, v180, v176, s67
v_perm_b32 v102, v180, v176, s68
v_perm_b32 v106, v181, v177, s67
v_perm_b32 v110, v181, v177, s68
v_perm_b32 v114, v182, v178, s67
v_perm_b32 v118, v182, v178, s68
v_perm_b32 v122, v183, v179, s67
v_perm_b32 v126, v183, v179, s68
v_perm_b32 v99, v188, v184, s67
v_perm_b32 v103, v188, v184, s68
v_perm_b32 v107, v189, v185, s67
v_perm_b32 v111, v189, v185, s68
v_perm_b32 v115, v190, v186, s67
v_perm_b32 v119, v190, v186, s68
v_perm_b32 v123, v191, v187, s67
v_perm_b32 v127, v191, v187, s68
v_mfma_f32_16x16x32_bf16 v[32:35], v[228:231], v[96:99], v[32:35]
v_mfma_f32_16x16x32_bf16 v[36:39], v[228:231], v[100:103], v[36:39]
v_mfma_f32_16x16x32_bf16 v[40:43], v[228:231], v[104:107], v[40:43]
v_mfma_f32_16x16x32_bf16 v[44:47], v[228:231], v[108:111], v[44:47]
v_mfma_f32_16x16x32_bf16 v[48:51], v[228:231], v[112:115], v[48:51]
v_mfma_f32_16x16x32_bf16 v[52:55], v[228:231], v[116:119], v[52:55]
v_mfma_f32_16x16x32_bf16 v[56:59], v[228:231], v[120:123], v[56:59]
v_mfma_f32_16x16x32_bf16 v[60:63], v[228:231], v[124:127], v[60:63]
v_lshlrev_b32 v30, 3, v3
v_lshrrev_b32 v30, v30, s31
v_bfe_u32 v31, v30, 4, 4
v_and_b32 v30, 15, v30
s_nop 0
v_mov_b32_dpp v28, v32 quad_perm:[0,1,2,3] row_mask:0x1 bank_mask:0xf
v_mov_b32_dpp v29, v36 quad_perm:[0,1,2,3] row_mask:0x1 bank_mask:0xf
v_mov_b32_dpp v28, v40 quad_perm:[0,1,2,3] row_mask:0x2 bank_mask:0xf
v_mov_b32_dpp v29, v44 quad_perm:[0,1,2,3] row_mask:0x2 bank_mask:0xf
v_mov_b32_dpp v28, v48 quad_perm:[0,1,2,3] row_mask:0x4 bank_mask:0xf
v_mov_b32_dpp v29, v52 quad_perm:[0,1,2,3] row_mask:0x4 bank_mask:0xf
v_mov_b32_dpp v28, v56 quad_perm:[0,1,2,3] row_mask:0x8 bank_mask:0xf
v_mov_b32_dpp v29, v60 quad_perm:[0,1,2,3] row_mask:0x8 bank_mask:0xf
v_add_u32 v28, 8, v28
v_and_or_b32 v28, v28, s69, v30
v_add_u32 v29, 8, v29
v_and_or_b32 v29, v29, s69, v31
buffer_store_dwordx2 v[28:29], v5, s[40:43], s56 offen sc1
s_branch L_r_join2
L_r_hi:
s_getreg_b32 s66, hwreg(HW_REG_XCC_ID, 0, 4)
s_mov_b32 s67, 0x05040100
s_mov_b32 s68, 0x07060302
s_mov_b32 s69, 0xfffffff0
s_mov_b32 s65, 0
v_lshlrev_b32 v4, 4, v3
v_lshlrev_b32 v5, 1, v2
v_lshl_add_u32 v5, v3, 3, v5
s_lshl_b32 s50, s3, 9
s_add_u32 s50, s50, 0x400
v_add_u32 v8, s50, v5
v_lshlrev_b32 v9, 2, v1
s_and_b32 s50, s3, 1
s_lshl_b32 s50, s50, 8
v_add_u32 v6, s50, v9
s_lshl_b32 s50, s3, 6
s_add_u32 s50, s50, 0x200
v_add_u32 v7, s50, v4
v_lshlrev_b32 v10, 3, v1
s_lshl_b32 s63, s48, 2
s_add_u32 s63, s63, s49
s_sub_u32 s63, s63, 28
s_and_b32 s63, s63, 15
v_lshrrev_b32 v22, 2, v2
v_add_u32 v22, v22, v3
v_lshlrev_b32 v23, 1, v22
v_lshlrev_b32 v25, 3, v22
v_lshlrev_b32 v22, 2, v22
v_lshl_add_u32 v14, v3, 9, v2
v_and_b32 v15, 1, v3
v_lshl_add_u32 v15, v15, 9, v2
s_lshl_b32 s51, s51, 3
s_lshr_b32 s50, s49, 2
s_add_u32 s51, s51, s50
s_lshl_b32 s57, s51, 9
s_add_u32 s57, s57, 0x10000
s_waitcnt lgkmcnt(0)
s_load_dword s30, s[28:29], 0
s_mov_b32 s40, s28
s_mov_b32 s41, s29
s_mov_b32 s42, 0x10000000
s_mov_b32 s43, 0x20000
s_mov_b32 s36, s22
s_mov_b32 s37, s23
s_mov_b32 s38, 0xc00000
s_mov_b32 s39, 0x20000
s_waitcnt lgkmcnt(0)
s_add_u32 s31, s30, 0x9e3779b9
s_mul_i32 s31, s31, 0x85ebca6b
s_lshr_b32 s50, s31, 15
s_xor_b32 s31, s31, s50
s_mul_i32 s31, s31, 0xc2b2ae35
s_lshr_b32 s50, s31, 13
s_xor_b32 s31, s31, s50
s_or_b32 s31, s31, 0x11111111
s_xor_b32 s31, s31, s30
v_and_b32 v11, 7, v1
v_lshlrev_b32 v11, 2, v11
v_bfe_u32 v11, s31, v11, 4
v_and_b32 v251, 1, v1
v_lshlrev_b32 v251, 4, v251
v_lshrrev_b32 v251, v251, s31
v_bfe_u32 v248, v251, 0, 4
v_bfe_u32 v249, v251, 4, 4
v_bfe_u32 v250, v251, 8, 4
v_bfe_u32 v251, v251, 12, 4
v_and_b32 v253, 3, v1
v_lshlrev_b32 v253, 3, v253
v_lshrrev_b32 v253, v253, s31
v_bfe_u32 v252, v253, 0, 4
v_bfe_u32 v253, v253, 4, 4
v_and_b32 v26, 1, v1
v_lshl_add_u32 v26, v26, 2, v3
v_lshlrev_b32 v26, 2, v26
v_bfe_u32 v26, s31, v26, 4
s_cmp_ge_u32 s3, 5
s_cbranch_scc1 L_r_h5
s_lshr_b32 s51, s63, 1
s_lshl_b32 s51, s51, 12
s_and_b32 s50, s63, 1
s_lshl_b32 s50, s50, 8
s_add_u32 s51, s51, s50
s_add_u32 s51, s51, 0x10000
s_add_u32 s52, s51, 0x8000
s_lshl_b32 s53, s63, 9
s_add_u32 s53, s53, 0x34000
s_cmp_lt_u32 s49, 28
s_cbranch_scc1 sk_4
buffer_load_dwordx4 v[32:35], v14, s[40:43], s51 offen offset:0 sc1
buffer_load_dwordx4 v[36:39], v14, s[40:43], s51 offen offset:2048 sc1
buffer_load_dwordx4 v[40:43], v14, s[40:43], s52 offen offset:0 sc1
buffer_load_dwordx4 v[44:47], v14, s[40:43], s52 offen offset:2048 sc1
buffer_load_dword v48, v10, s[40:43], s53 offen offset:0 sc1
s_barrier
s_mov_b32 s64, 0
poll_5:
buffer_load_dwordx4 v[32:35], v14, s[40:43], s51 offen offset:0 sc1
buffer_load_dwordx4 v[36:39], v14, s[40:43], s51 offen offset:2048 sc1
buffer_load_dwordx4 v[40:43], v14, s[40:43], s52 offen offset:0 sc1
buffer_load_dwordx4 v[44:47], v14, s[40:43], s52 offen offset:2048 sc1
s_waitcnt vmcnt(0)
pchk_7:
v_xor_b32 v32, v248, v32
v_xor_b32 v33, v249, v33
v_xor_b32 v34, v250, v34
v_xor_b32 v35, v251, v35
v_xor_b32 v36, v248, v36
v_xor_b32 v37, v249, v37
v_xor_b32 v38, v250, v38
v_xor_b32 v39, v251, v39
v_xor_b32 v40, v248, v40
v_xor_b32 v41, v249, v41
v_xor_b32 v42, v250, v42
v_xor_b32 v43, v251, v43
v_xor_b32 v44, v248, v44
v_xor_b32 v45, v249, v45
v_xor_b32 v46, v250, v46
v_xor_b32 v47, v251, v47
v_or3_b32 v28, v32, v33, v34
v_or3_b32 v28, v28, v35, v36
v_or3_b32 v28, v28, v37, v38
v_or3_b32 v28, v28, v39, v40
v_or3_b32 v28, v28, v41, v42
v_or3_b32 v28, v28, v43, v44
v_or3_b32 v28, v28, v45, v46
v_or_b32 v28, v28, v47
v_and_b32 v28, 15, v28
v_cmp_ne_u32 vcc, 0, v28
s_cbranch_vccz pdone_6
s_add_u32 s64, s64, 1
s_cmp_lg_u32 s64, 24
s_cbranch_scc1 sk_8
s_barrier
sk_8:
s_cmp_lt_u32 s64, 1000000
s_cbranch_scc1 poll_5
pdone_6:
v_add_f32 v32, v32, v36
v_add_f32 v33, v33, v37
v_add_f32 v34, v34, v38
v_add_f32 v35, v35, v39
v_add_f32 v36, v40, v44
v_add_f32 v37, v41, v45
v_add_f32 v38, v42, v46
v_add_f32 v39, v43, v47
v_permlane16_swap_b32 v32, v33
v_permlane16_swap_b32 v34, v35
v_permlane16_swap_b32 v36, v37
v_permlane16_swap_b32 v38, v39
v_add_f32 v32, v32, v33
v_add_f32 v34, v34, v35
v_add_f32 v36, v36, v37
v_add_f32 v38, v38, v39
s_nop 0
v_permlane32_swap_b32 v32, v34
v_permlane32_swap_b32 v36, v38
v_add_f32 v32, v32, v34
v_add_f32 v36, v36, v38
v_cvt_pk_bf16_f32 v36, v36, v36
v_and_b32 v36, 0xffff0000, v36
v_add_f32 v36, 1.0, v36
v_mov_b32 v33, s31
v_cvt_pk_bf16_f32 v32, v32, v36
buffer_store_dwordx2 v[32:33], v25, s[40:43], s53 offen sc1
s_cmp_ge_u32 s64, 24
s_cbranch_scc1 sk_9
s_barrier
sk_9:
s_branch L_r_join
sk_4:
s_barrier
s_barrier
s_branch L_r_join
L_r_h5:
s_barrier
s_cmp_lg_u32 s3, 6
s_cbranch_scc1 sk_10
ds_read_b64 v[48:49], v10 offset:1024
ds_read_b64 v[50:51], v10 offset:1536
ds_read_b64 v[52:53], v10 offset:2048
ds_read_b64 v[54:55], v10 offset:2560
s_waitcnt lgkmcnt(0)
v_add_f32 v48, v48, v50
v_add_f32 v49, v49, v51
v_add_f32 v52, v52, v54
v_add_f32 v53, v53, v55
v_add_f32 v48, v48, v52
v_add_f32 v49, v49, v53
v_add_u32 v48, 8, v48
v_and_or_b32 v48, v48, s69, v252
v_add_u32 v49, 8, v49
v_and_or_b32 v49, v49, s69, v253
buffer_store_dwordx2 v[48:49], v10, s[40:43], s57 offen
sk_10:
s_cmp_lg_u32 s3, 7
s_cbranch_scc1 sk_11
s_and_b32 s50, s2, 7
s_lshl_b32 s50, s50, 5
s_add_u32 s50, s50, s49
s_lshl_b32 s50, s50, 3
s_add_u32 s50, s50, 0x3a000
v_mov_b32 v28, s66
v_mov_b32 v29, s31
s_mov_b64 exec, 1
buffer_store_dwordx2 v[28:29], v10, s[40:43], s50 offen
s_mov_b64 exec, -1
sk_11:
s_barrier
v_mov_b32 v242, v48
v_mov_b32 v243, v49
s_mov_b32 s33, s57
s_cmp_lg_u32 s3, 6
s_cbranch_scc1 sk_12
s_cmp_lt_u32 s49, 28
s_cbranch_scc1 sk_12
v_and_b32 v104, 31, v1
v_lshlrev_b32 v104, 3, v104
s_and_b32 s50, s2, 7
s_lshl_b32 s50, s50, 8
s_add_u32 s50, s50, 0x3a000
buffer_load_dwordx2 v[106:107], v104, s[40:43], s50 offen offset:0 sc1
s_waitcnt vmcnt(0)
v_xor_b32 v106, s66, v106
v_xor_b32 v107, s31, v107
v_or_b32 v106, v106, v107
v_cmp_ne_u32 vcc, 0, v106
s_cmp_eq_u64 vcc, 0
s_cselect_b32 s65, 1, 0
s_cmp_eq_u32 s65, 1
s_cbranch_scc1 sk_13
buffer_store_dwordx2 v[242:243], v10, s[40:43], s57 offen sc1
sk_13:
sk_12:
L_r_join:
s_barrier
L_r_join2:
s_mov_b32 s30, s33
s_mov_b32 s50, 16384
v_mul_lo_u32 v12, v3, s50
v_add_u32 v12, v12, v2
s_and_b32 s59, s49, 7
s_xor_b32 s59, s59, s3
s_lshr_b32 s62, s49, 3
s_lshl_b32 s50, s48, 2
s_add_u32 s62, s62, s50
s_and_b32 s50, s59, 1
s_lshl_b32 s50, s50, 2
s_lshr_b32 s59, s59, 1
s_add_u32 s59, s59, s50
s_lshl_b32 s59, s59, 2
s_lshr_b32 s50, s49, 3
s_add_u32 s59, s59, s50
s_lshl_b32 s50, s48, 5
s_add_u32 s59, s59, s50
s_and_b32 s58, s59, 3
s_lshl_b32 s58, s58, 5
s_bfe_u32 s50, s59, 0x30002
s_add_u32 s58, s58, s50
s_lshl_b32 s50, s48, 10
s_add_u32 s58, s58, s50
s_lshl_b32 s58, s58, 11
s_and_b32 s61, s49, 7
s_cmp_eq_u32 s49, 29
s_cselect_b32 s61, 2, s61
s_cmp_eq_u32 s49, 26
s_cselect_b32 s61, 5, s61
s_lshl_b32 s50, s61, 8
s_add_u32 s58, s58, s50
s_lshl_b32 s61, s61, 4
s_add_u32 s61, s61, s62
s_lshl_b32 s61, s61, 9
s_add_u32 s61, s61, 0x40000
s_lshl_b32 s60, s59, 7
s_add_u32 s60, s60, 0x30000
s_mov_b32 s32, s12
s_mov_b32 s33, s13
s_mov_b32 s34, 0x800000
s_mov_b32 s35, 0x20000
s_mov_b32 s44, s8
s_mov_b32 s45, s9
s_mov_b32 s46, 0x4000000
s_mov_b32 s47, 0x20000
s_lshl_b32 s55, s48, 5
s_add_u32 s55, s55, s49
v_lshlrev_b32 v24, 4, v1
s_cmp_lt_u32 s3, 4
s_cbranch_scc1 L_r_m
s_sub_u32 s53, s3, 4
s_lshl_b32 s56, s48, 24
s_add_u32 s56, s56, 0xF00000
s_lshl_b32 s50, s49, 15
s_add_u32 s56, s56, s50
s_lshl_b32 s50, s53, 13
s_add_u32 s56, s56, s50
s_add_u32 s57, s56, 4096
s_lshl_b32 s52, s55, 2
s_add_u32 s52, s52, s53
s_lshl_b32 s52, s52, 10
s_add_u32 s52, s52, 0x180000
buffer_load_dwordx4 v[192:195], v14, s[44:47], s56 offen offset:0 nt
buffer_load_dwordx4 v[196:199], v14, s[44:47], s56 offen offset:2048 nt
buffer_load_dwordx4 v[200:203], v14, s[44:47], s57 offen offset:0 nt
buffer_load_dwordx4 v[204:207], v14, s[44:47], s57 offen offset:2048 nt
buffer_load_dwordx4 v[208:211], v14, s[44:47], s56 offen offset:256 nt
buffer_load_dwordx4 v[212:215], v14, s[44:47], s56 offen offset:2304 nt
buffer_load_dwordx4 v[216:219], v14, s[44:47], s57 offen offset:256 nt
buffer_load_dwordx4 v[220:223], v14, s[44:47], s57 offen offset:2304 nt
buffer_load_dwordx4 v[64:67], v12, s[32:35], s58 offen nt
s_add_u32 s50, s58, 0x40000
buffer_load_dwordx4 v[68:71], v12, s[32:35], s50 offen nt
s_add_u32 s50, s58, 0x80000
buffer_load_dwordx4 v[72:75], v12, s[32:35], s50 offen nt
s_add_u32 s50, s58, 0xc0000
buffer_load_dwordx4 v[76:79], v12, s[32:35], s50 offen nt
s_add_u32 s50, s58, 0x100000
buffer_load_dwordx4 v[80:83], v12, s[32:35], s50 offen nt
s_add_u32 s50, s58, 0x140000
buffer_load_dwordx4 v[84:87], v12, s[32:35], s50 offen nt
s_add_u32 s50, s58, 0x180000
buffer_load_dwordx4 v[88:91], v12, s[32:35], s50 offen nt
s_add_u32 s50, s58, 0x1c0000
buffer_load_dwordx4 v[92:95], v12, s[32:35], s50 offen nt
s_barrier
v_and_b32 v236, 31, v1
v_lshlrev_b32 v236, 3, v236
s_and_b32 s50, s2, 7
s_lshl_b32 s50, s50, 8
s_add_u32 s50, s50, 0x3a000
buffer_load_dwordx2 v[238:239], v236, s[40:43], s50 offen offset:0 sc1
v_and_b32 v20, 7, v1
v_lshlrev_b32 v18, 2, v20
v_lshlrev_b32 v19, 4, v20
v_lshl_add_u32 v19, v3, 12, v19
v_lshl_add_u32 v21, v3, 3, v20
v_lshlrev_b32 v21, 4, v21
s_lshl_b32 s50, s3, 12
v_add_u32 v17, s50, v24
s_lshl_b32 s51, s48, 17
s_lshl_b32 s50, s3, 14
s_add_u32 s51, s51, s50
s_lshl_b32 s50, s49, 7
s_add_u32 s51, s51, s50
s_add_u32 s51, s51, 0x100000
v_mov_b32 v59, s31
s_mov_b32 s56, 0x00ff00ff
s_mov_b32 s57, 0x00ff00ff
s_lshl_b32 s50, s53, 10
v_add_u32 v16, s50, v24
v_bfe_u32 v20, v1, 3, 1
v_lshl_add_u32 v20, v20, 3, v21
s_lshl_b32 s50, s53, 9
v_add_u32 v20, s50, v20
s_mov_b32 s64, 0
buffer_load_dwordx4 v[32:35], v24, s[40:43], s52 offen offset:0 sc1
s_waitcnt vmcnt(10)
v_perm_b32 v96, v196, v192, s67
v_perm_b32 v100, v196, v192, s68
v_perm_b32 v104, v197, v193, s67
v_perm_b32 v108, v197, v193, s68
v_perm_b32 v112, v198, v194, s67
v_perm_b32 v116, v198, v194, s68
v_perm_b32 v120, v199, v195, s67
v_perm_b32 v124, v199, v195, s68
v_perm_b32 v97, v204, v200, s67
v_perm_b32 v101, v204, v200, s68
v_perm_b32 v105, v205, v201, s67
v_perm_b32 v109, v205, v201, s68
v_perm_b32 v113, v206, v202, s67
v_perm_b32 v117, v206, v202, s68
v_perm_b32 v121, v207, v203, s67
v_perm_b32 v125, v207, v203, s68
v_perm_b32 v98, v212, v208, s67
v_perm_b32 v102, v212, v208, s68
v_perm_b32 v106, v213, v209, s67
v_perm_b32 v110, v213, v209, s68
v_perm_b32 v114, v214, v210, s67
v_perm_b32 v118, v214, v210, s68
v_perm_b32 v122, v215, v211, s67
v_perm_b32 v126, v215, v211, s68
v_perm_b32 v99, v220, v216, s67
v_perm_b32 v103, v220, v216, s68
v_perm_b32 v107, v221, v217, s67
v_perm_b32 v111, v221, v217, s68
v_perm_b32 v115, v222, v218, s67
v_perm_b32 v119, v222, v218, s68
v_perm_b32 v123, v223, v219, s67
v_perm_b32 v127, v223, v219, s68
ds_write_b128 v16, v[96:99] offset:16384
ds_write_b128 v16, v[100:103] offset:20480
ds_write_b128 v16, v[104:107] offset:24576
ds_write_b128 v16, v[108:111] offset:28672
ds_write_b128 v16, v[112:115] offset:32768
ds_write_b128 v16, v[116:119] offset:36864
ds_write_b128 v16, v[120:123] offset:40960
ds_write_b128 v16, v[124:127] offset:45056
s_waitcnt lgkmcnt(0)
s_barrier
ds_read_b128 v[160:163], v17 offset:16384
ds_read_b128 v[164:167], v17 offset:17408
ds_read_b128 v[168:171], v17 offset:18432
ds_read_b128 v[172:175], v17 offset:19456
s_waitcnt vmcnt(8)
v_perm_b32 v128, v68, v64, s67
v_perm_b32 v132, v68, v64, s68
v_perm_b32 v136, v69, v65, s67
v_perm_b32 v140, v69, v65, s68
v_perm_b32 v144, v70, v66, s67
v_perm_b32 v148, v70, v66, s68
v_perm_b32 v152, v71, v67, s67
v_perm_b32 v156, v71, v67, s68
s_waitcnt vmcnt(6)
v_perm_b32 v129, v76, v72, s67
v_perm_b32 v133, v76, v72, s68
v_perm_b32 v137, v77, v73, s67
v_perm_b32 v141, v77, v73, s68
v_perm_b32 v145, v78, v74, s67
v_perm_b32 v149, v78, v74, s68
v_perm_b32 v153, v79, v75, s67
v_perm_b32 v157, v79, v75, s68
s_waitcnt vmcnt(4)
v_perm_b32 v130, v84, v80, s67
v_perm_b32 v134, v84, v80, s68
v_perm_b32 v138, v85, v81, s67
v_perm_b32 v142, v85, v81, s68
v_perm_b32 v146, v86, v82, s67
v_perm_b32 v150, v86, v82, s68
v_perm_b32 v154, v87, v83, s67
v_perm_b32 v158, v87, v83, s68
s_waitcnt vmcnt(2)
v_perm_b32 v131, v92, v88, s67
v_perm_b32 v135, v92, v88, s68
v_perm_b32 v139, v93, v89, s67
v_perm_b32 v143, v93, v89, s68
v_perm_b32 v147, v94, v90, s67
v_perm_b32 v151, v94, v90, s68
v_perm_b32 v155, v95, v91, s67
v_perm_b32 v159, v95, v91, s68
s_waitcnt vmcnt(1)
v_xor_b32 v238, s66, v238
v_xor_b32 v239, s31, v239
v_or_b32 v238, v238, v239
v_cmp_ne_u32 vcc, 0, v238
s_cmp_eq_u64 vcc, 0
s_cselect_b32 s65, 1, 0
s_cmp_lg_u32 s3, 6
s_cbranch_scc1 sk_17
s_cmp_eq_u32 s65, 1
s_cbranch_scc1 sk_18
buffer_store_dwordx2 v[242:243], v10, s[40:43], s30 offen sc1
sk_18:
sk_17:
s_waitcnt vmcnt(0)
s_branch pchk_16
poll_14:
buffer_load_dwordx4 v[32:35], v24, s[40:43], s52 offen offset:0 sc1
s_waitcnt vmcnt(0)
pchk_16:
v_cmp_ne_u32 vcc, s31, v35
s_cbranch_vccz pdone_15
s_add_u32 s64, s64, 1
s_cmp_lt_u32 s64, 1000000
s_cbranch_scc1 poll_14
pdone_15:
ds_write_b64 v20, v[32:33] offset:8192
ds_write_b32 v18, v34 offset:128
s_waitcnt lgkmcnt(0)
s_branch L_r_pv
L_r_m:
s_lshl_b32 s52, s55, 12
s_lshl_b32 s50, s3, 10
s_add_u32 s52, s52, s50
s_add_u32 s52, s52, 0x100000
s_lshl_b32 s53, s55, 7
s_add_u32 s53, s53, 0x30000
s_lshl_b32 s54, s48, 1
s_and_b32 s50, s49, 1
s_add_u32 s54, s54, s50
s_lshl_b32 s54, s54, 4
s_lshr_b32 s50, s49, 1
s_add_u32 s54, s54, s50
s_lshl_b32 s54, s54, 9
s_add_u32 s54, s54, 0x50000
s_cmp_eq_u32 s3, 1
s_cselect_b32 s53, s54, s53
s_cmp_eq_u32 s3, 2
s_cselect_b32 s53, s61, s53
buffer_load_dwordx4 v[64:67], v12, s[32:35], s58 offen nt
s_add_u32 s50, s58, 0x40000
buffer_load_dwordx4 v[68:71], v12, s[32:35], s50 offen nt
s_add_u32 s50, s58, 0x80000
buffer_load_dwordx4 v[72:75], v12, s[32:35], s50 offen nt
s_add_u32 s50, s58, 0xc0000
buffer_load_dwordx4 v[76:79], v12, s[32:35], s50 offen nt
s_add_u32 s50, s58, 0x100000
buffer_load_dwordx4 v[80:83], v12, s[32:35], s50 offen nt
s_add_u32 s50, s58, 0x140000
buffer_load_dwordx4 v[84:87], v12, s[32:35], s50 offen nt
s_add_u32 s50, s58, 0x180000
buffer_load_dwordx4 v[88:91], v12, s[32:35], s50 offen nt
s_add_u32 s50, s58, 0x1c0000
buffer_load_dwordx4 v[92:95], v12, s[32:35], s50 offen nt
buffer_load_dwordx4 v[232:235], v24, s[40:43], s52 offen offset:0 sc1
buffer_load_dword v240, v10, s[40:43], s53 offen offset:0 sc1
s_barrier
v_and_b32 v236, 31, v1
v_lshlrev_b32 v236, 3, v236
s_and_b32 s50, s2, 7
s_lshl_b32 s50, s50, 8
s_add_u32 s50, s50, 0x3a000
buffer_load_dwordx2 v[238:239], v236, s[40:43], s50 offen offset:0 sc1
v_and_b32 v20, 7, v1
v_lshlrev_b32 v18, 2, v20
v_lshlrev_b32 v19, 4, v20
v_lshl_add_u32 v19, v3, 12, v19
v_lshl_add_u32 v21, v3, 3, v20
v_lshlrev_b32 v21, 4, v21
s_lshl_b32 s50, s3, 12
v_add_u32 v17, s50, v24
s_lshl_b32 s51, s48, 17
s_lshl_b32 s50, s3, 14
s_add_u32 s51, s51, s50
s_lshl_b32 s50, s49, 7
s_add_u32 s51, s51, s50
s_add_u32 s51, s51, 0x100000
v_mov_b32 v59, s31
s_mov_b32 s56, 0x00ff00ff
s_mov_b32 s57, 0x00ff00ff
s_barrier
ds_read_b128 v[160:163], v17 offset:16384
ds_read_b128 v[164:167], v17 offset:17408
ds_read_b128 v[168:171], v17 offset:18432
ds_read_b128 v[172:175], v17 offset:19456
s_waitcnt vmcnt(9)
v_perm_b32 v128, v68, v64, s67
v_perm_b32 v132, v68, v64, s68
v_perm_b32 v136, v69, v65, s67
v_perm_b32 v140, v69, v65, s68
v_perm_b32 v144, v70, v66, s67
v_perm_b32 v148, v70, v66, s68
v_perm_b32 v152, v71, v67, s67
v_perm_b32 v156, v71, v67, s68
s_waitcnt vmcnt(7)
v_perm_b32 v129, v76, v72, s67
v_perm_b32 v133, v76, v72, s68
v_perm_b32 v137, v77, v73, s67
v_perm_b32 v141, v77, v73, s68
v_perm_b32 v145, v78, v74, s67
v_perm_b32 v149, v78, v74, s68
v_perm_b32 v153, v79, v75, s67
v_perm_b32 v157, v79, v75, s68
s_waitcnt vmcnt(5)
v_perm_b32 v130, v84, v80, s67
v_perm_b32 v134, v84, v80, s68
v_perm_b32 v138, v85, v81, s67
v_perm_b32 v142, v85, v81, s68
v_perm_b32 v146, v86, v82, s67
v_perm_b32 v150, v86, v82, s68
v_perm_b32 v154, v87, v83, s67
v_perm_b32 v158, v87, v83, s68
s_waitcnt vmcnt(3)
v_perm_b32 v131, v92, v88, s67
v_perm_b32 v135, v92, v88, s68
v_perm_b32 v139, v93, v89, s67
v_perm_b32 v143, v93, v89, s68
v_perm_b32 v147, v94, v90, s67
v_perm_b32 v151, v94, v90, s68
v_perm_b32 v155, v95, v91, s67
v_perm_b32 v159, v95, v91, s68
s_waitcnt vmcnt(0)
v_xor_b32 v238, s66, v238
v_xor_b32 v239, s31, v239
v_or_b32 v238, v238, v239
v_cmp_ne_u32 vcc, 0, v238
s_cmp_eq_u64 vcc, 0
s_cselect_b32 s65, 1, 0
L_r_pv:
s_barrier
ds_read_b128 v[32:35], v21 offset:8192
ds_read_b128 v[36:39], v21 offset:8704
ds_read_b128 v[40:43], v21 offset:9216
ds_read_b128 v[44:47], v21 offset:9728
ds_read_b32 v56, v18 offset:128
s_waitcnt lgkmcnt(4)
v_mfma_f32_16x16x32_bf16 v[48:51], v[160:163], v[32:35], 0
s_waitcnt lgkmcnt(3)
v_mfma_f32_16x16x32_bf16 v[48:51], v[164:167], v[36:39], v[48:51]
s_waitcnt lgkmcnt(2)
v_mfma_f32_16x16x32_bf16 v[48:51], v[168:171], v[40:43], v[48:51]
s_waitcnt lgkmcnt(1)
v_mfma_f32_16x16x32_bf16 v[48:51], v[172:175], v[44:47], v[48:51]
s_mov_b64 exec, s[56:57]
s_waitcnt lgkmcnt(0)
s_nop 5
v_cvt_pk_bf16_f32 v57, v48, v49
v_cvt_pk_bf16_f32 v58, v50, v51
buffer_store_dwordx4 v[56:59], v19, s[40:43], s51 offen
s_cmp_eq_u32 s65, 1
s_cbranch_scc1 sk_19
buffer_store_dwordx4 v[56:59], v19, s[40:43], s51 offen sc1
sk_19:
s_mov_b64 exec, -1
s_cmp_lg_u32 s3, 0
s_cbranch_scc1 sk_20
v_lshlrev_b32 v24, 4, v1
v_lshlrev_b32 v20, 5, v3
v_and_b32 v21, 7, v1
v_lshl_add_u32 v20, v21, 2, v20
s_lshl_b32 s51, s48, 5
s_add_u32 s51, s51, s49
s_lshl_b32 s51, s51, 7
s_add_u32 s51, s51, 0x30000
s_mov_b32 s54, 0x00550055
s_mov_b32 s55, 0x00550055
s_lshl_b32 s52, s48, 17
s_lshl_b32 s50, s49, 12
s_add_u32 s52, s52, s50
s_add_u32 s52, s52, 0x100000
s_mov_b32 s64, 0
poll_21:
buffer_load_dwordx4 v[64:67], v24, s[40:43], s52 offen offset:0 sc1
buffer_load_dwordx4 v[68:71], v24, s[40:43], s52 offen offset:1024 sc1
buffer_load_dwordx4 v[72:75], v24, s[40:43], s52 offen offset:2048 sc1
buffer_load_dwordx4 v[76:79], v24, s[40:43], s52 offen offset:3072 sc1
s_waitcnt vmcnt(0)
pchk_23:
v_xor_b32 v67, s31, v67
v_xor_b32 v71, s31, v71
v_xor_b32 v75, s31, v75
v_xor_b32 v79, s31, v79
v_or3_b32 v28, v67, v71, v75
v_or_b32 v28, v28, v79
v_cmp_ne_u32 vcc, 0, v28
s_cbranch_vccz pdone_22
s_add_u32 s64, s64, 1
s_cmp_lt_u32 s64, 1000000
s_cbranch_scc1 poll_21
pdone_22:
v_max3_f32 v32, v64, v68, v72
v_max_f32 v32, v32, v76
v_lshlrev_b32 v80, 16, v65
v_and_b32 v81, 0xffff0000, v65
v_lshlrev_b32 v84, 16, v69
v_and_b32 v85, 0xffff0000, v69
v_lshlrev_b32 v88, 16, v73
v_and_b32 v89, 0xffff0000, v73
v_lshlrev_b32 v92, 16, v77
v_and_b32 v93, 0xffff0000, v77
v_max_f32_dpp v32, v32, v32 row_ror:8 row_mask:0xf bank_mask:0xf
v_mov_b32 v33, v32
v_lshlrev_b32 v82, 16, v66
v_and_b32 v83, 0xffff0000, v66
v_lshlrev_b32 v86, 16, v70
v_and_b32 v87, 0xffff0000, v70
v_permlane16_swap_b32 v32, v33
v_max_f32 v32, v32, v33
v_mov_b32 v33, v32
v_lshlrev_b32 v90, 16, v74
v_and_b32 v91, 0xffff0000, v74
v_lshlrev_b32 v94, 16, v78
v_and_b32 v95, 0xffff0000, v78
v_permlane32_swap_b32 v32, v33
v_max_f32 v32, v32, v33
v_sub_f32 v36, v64, v32
v_sub_f32 v37, v68, v32
v_sub_f32 v38, v72, v32
v_sub_f32 v39, v76, v32
v_exp_f32 v36, v36
v_exp_f32 v37, v37
v_exp_f32 v38, v38
v_exp_f32 v39, v39
s_nop 0
v_add_f32 v34, v36, v37
v_add_f32 v35, v38, v39
v_mul_f32 v40, v36, v80
v_mul_f32 v41, v36, v81
v_mul_f32 v42, v36, v82
v_mul_f32 v43, v36, v83
v_add_f32 v34, v34, v35
v_fmac_f32 v40, v37, v84
v_fmac_f32 v41, v37, v85
v_fmac_f32 v42, v37, v86
v_fmac_f32 v43, v37, v87
v_fmac_f32 v40, v38, v88
v_fmac_f32 v41, v38, v89
v_fmac_f32 v42, v38, v90
v_fmac_f32 v43, v38, v91
v_fmac_f32 v40, v39, v92
v_fmac_f32 v41, v39, v93
v_fmac_f32 v42, v39, v94
v_fmac_f32 v43, v39, v95
v_add_f32_dpp v34, v34, v34 row_ror:8 row_mask:0xf bank_mask:0xf
v_mov_b32 v35, v34
v_permlane16_swap_b32 v40, v41
v_permlane16_swap_b32 v42, v43
v_permlane16_swap_b32 v34, v35
v_add_f32 v40, v40, v41
v_add_f32 v42, v42, v43
v_add_f32 v34, v34, v35
v_mov_b32 v35, v34
s_nop 0
v_permlane32_swap_b32 v40, v42
v_permlane32_swap_b32 v34, v35
v_add_f32 v40, v40, v42
v_add_f32 v34, v34, v35
v_rcp_f32 v34, v34
v_mov_b32 v43, s31
v_add_f32_dpp v40, v40, v40 row_ror:8 row_mask:0xf bank_mask:0xf
v_mul_f32 v40, v40, v34
s_nop 1
v_mov_b32_dpp v41, v40 quad_perm:[1,0,3,2] row_mask:0xf bank_mask:0xf
v_cvt_pk_bf16_f32 v42, v40, v41
s_mov_b64 exec, s[54:55]
buffer_store_dwordx2 v[42:43], v20, s[40:43], s51 offen
s_cmp_eq_u32 s65, 1
s_cbranch_scc1 sk_24
buffer_store_dwordx2 v[42:43], v20, s[40:43], s51 offen sc1
sk_24:
s_mov_b64 exec, -1
sk_20:
L_r_o:
v_lshlrev_b32 v21, 1, v4
s_mov_b32 s64, 0
poll_25:
buffer_load_dwordx4 v[32:35], v21, s[40:43], s60 offen offset:0 sc1
buffer_load_dwordx4 v[36:39], v21, s[40:43], s60 offen offset:16 sc1
s_waitcnt vmcnt(0)
pchk_27:
v_xor_b32 v33, s31, v33
v_xor_b32 v35, s31, v35
v_xor_b32 v37, s31, v37
v_xor_b32 v39, s31, v39
v_or3_b32 v28, v33, v35, v37
v_or_b32 v28, v28, v39
v_cmp_ne_u32 vcc, 0, v28
s_cbranch_vccz pdone_26
s_add_u32 s64, s64, 1
s_cmp_lt_u32 s64, 1000000
s_cbranch_scc1 poll_25
pdone_26:
v_mov_b32 v16, v32
v_mov_b32 v17, v34
v_mov_b32 v18, v36
v_mov_b32 v19, v38
s_nop 1
v_mfma_f32_16x16x32_bf16 v[32:35], v[16:19], v[128:131], 0
v_mfma_f32_16x16x32_bf16 v[36:39], v[16:19], v[132:135], 0
v_mfma_f32_16x16x32_bf16 v[40:43], v[16:19], v[136:139], 0
v_mfma_f32_16x16x32_bf16 v[44:47], v[16:19], v[140:143], 0
v_mfma_f32_16x16x32_bf16 v[48:51], v[16:19], v[144:147], 0
v_mfma_f32_16x16x32_bf16 v[52:55], v[16:19], v[148:151], 0
v_mfma_f32_16x16x32_bf16 v[56:59], v[16:19], v[152:155], 0
v_mfma_f32_16x16x32_bf16 v[60:63], v[16:19], v[156:159], 0
s_nop 0
v_mov_b32_dpp v28, v32 quad_perm:[0,1,2,3] row_mask:0x1 bank_mask:0xf
v_mov_b32_dpp v29, v36 quad_perm:[0,1,2,3] row_mask:0x1 bank_mask:0xf
v_mov_b32_dpp v28, v40 quad_perm:[0,1,2,3] row_mask:0x2 bank_mask:0xf
v_mov_b32_dpp v29, v44 quad_perm:[0,1,2,3] row_mask:0x2 bank_mask:0xf
v_mov_b32_dpp v28, v48 quad_perm:[0,1,2,3] row_mask:0x4 bank_mask:0xf
v_mov_b32_dpp v29, v52 quad_perm:[0,1,2,3] row_mask:0x4 bank_mask:0xf
v_mov_b32_dpp v28, v56 quad_perm:[0,1,2,3] row_mask:0x8 bank_mask:0xf
v_mov_b32_dpp v29, v60 quad_perm:[0,1,2,3] row_mask:0x8 bank_mask:0xf
ds_write_b64 v8, v[28:29]
s_lshr_b32 s50, s3, 1
s_waitcnt lgkmcnt(0)
s_barrier
s_cmp_lg_u32 s50, 0
s_cbranch_scc1 sk_28
ds_read2st64_b32 v[48:49], v6 offset0:4 offset1:6
ds_read2st64_b32 v[50:51], v6 offset0:8 offset1:10
ds_read2st64_b32 v[52:53], v6 offset0:12 offset1:14
ds_read2st64_b32 v[54:55], v6 offset0:16 offset1:18
s_waitcnt lgkmcnt(2)
v_add_f32 v48, v48, v49
v_add_f32 v50, v50, v51
s_waitcnt lgkmcnt(0)
v_add_f32 v52, v52, v53
v_add_f32 v54, v54, v55
v_add_f32 v48, v48, v50
v_add_f32 v52, v52, v54
v_add_f32 v48, v48, v52
v_add_u32 v48, 8, v48
v_and_or_b32 v48, v48, s69, v11
buffer_store_dword v48, v6, s[40:43], s61 offen sc1
sk_28:
s_lshr_b32 s62, s49, 1
s_and_b32 s59, s49, 7
s_xor_b32 s59, s59, s3
s_lshl_b32 s50, s62, 3
s_add_u32 s59, s59, s50
s_lshl_b32 s58, s59, 16
s_lshl_b32 s61, s48, 1
s_and_b32 s50, s49, 1
s_add_u32 s61, s61, s50
s_lshl_b32 s50, s61, 8
s_add_u32 s58, s58, s50
s_lshl_b32 s61, s61, 4
s_add_u32 s61, s61, s62
s_lshl_b32 s61, s61, 9
s_add_u32 s61, s61, 0x50000
s_mov_b32 s32, s18
s_mov_b32 s33, s19
s_mov_b32 s34, 0x700000
s_mov_b32 s35, 0x20000
s_barrier
s_cmp_ge_u32 s49, 28
s_cbranch_scc1 L_leader
s_cmp_ge_u32 s3, 2
s_cbranch_scc1 sk_29
buffer_load_dwordx4 v[64:67], v12, s[32:35], s58 offen nt
s_add_u32 s50, s58, 0x800
buffer_load_dwordx4 v[68:71], v12, s[32:35], s50 offen nt
s_add_u32 s50, s58, 0x1000
buffer_load_dwordx4 v[72:75], v12, s[32:35], s50 offen nt
s_add_u32 s50, s58, 0x1800
buffer_load_dwordx4 v[76:79], v12, s[32:35], s50 offen nt
s_add_u32 s50, s58, 0x2000
buffer_load_dwordx4 v[80:83], v12, s[32:35], s50 offen nt
s_add_u32 s50, s58, 0x2800
buffer_load_dwordx4 v[84:87], v12, s[32:35], s50 offen nt
s_add_u32 s50, s58, 0x3000
buffer_load_dwordx4 v[88:91], v12, s[32:35], s50 offen nt
s_add_u32 s50, s58, 0x3800
buffer_load_dwordx4 v[92:95], v12, s[32:35], s50 offen nt
s_waitcnt vmcnt(0)
s_barrier
s_branch w2j_30
sk_29:
s_barrier
buffer_load_dwordx4 v[64:67], v12, s[32:35], s58 offen nt
s_add_u32 s50, s58, 0x800
buffer_load_dwordx4 v[68:71], v12, s[32:35], s50 offen nt
s_add_u32 s50, s58, 0x1000
buffer_load_dwordx4 v[72:75], v12, s[32:35], s50 offen nt
s_add_u32 s50, s58, 0x1800
buffer_load_dwordx4 v[76:79], v12, s[32:35], s50 offen nt
s_add_u32 s50, s58, 0x2000
buffer_load_dwordx4 v[80:83], v12, s[32:35], s50 offen nt
s_add_u32 s50, s58, 0x2800
buffer_load_dwordx4 v[84:87], v12, s[32:35], s50 offen nt
s_add_u32 s50, s58, 0x3000
buffer_load_dwordx4 v[88:91], v12, s[32:35], s50 offen nt
s_add_u32 s50, s58, 0x3800
buffer_load_dwordx4 v[92:95], v12, s[32:35], s50 offen nt
w2j_30:
s_barrier
s_lshr_b32 s60, s59, 2
s_lshl_b32 s60, s60, 11
s_and_b32 s50, s59, 3
s_lshl_b32 s50, s50, 7
s_add_u32 s60, s60, s50
s_add_u32 s60, s60, 0x60000
v_lshrrev_b32 v20, 1, v2
v_lshl_add_u32 v21, v3, 9, v20
v_lshrrev_b32 v22, 1, v20
v_and_b32 v23, 1, v3
v_lshl_add_u32 v22, v23, 1, v22
s_lshl_b32 s50, s3, 6
s_add_u32 s50, s50, 0x200
v_add_u32 v22, s50, v22
s_mov_b32 s64, 0
buffer_load_dwordx2 v[32:33], v21, s[40:43], s60 offen offset:0 sc1
s_waitcnt vmcnt(7)
v_perm_b32 v128, v68, v64, s67
v_perm_b32 v132, v68, v64, s68
v_perm_b32 v136, v69, v65, s67
v_perm_b32 v140, v69, v65, s68
v_perm_b32 v144, v70, v66, s67
v_perm_b32 v148, v70, v66, s68
v_perm_b32 v152, v71, v67, s67
v_perm_b32 v156, v71, v67, s68
s_waitcnt vmcnt(5)
v_perm_b32 v129, v76, v72, s67
v_perm_b32 v133, v76, v72, s68
v_perm_b32 v137, v77, v73, s67
v_perm_b32 v141, v77, v73, s68
v_perm_b32 v145, v78, v74, s67
v_perm_b32 v149, v78, v74, s68
v_perm_b32 v153, v79, v75, s67
v_perm_b32 v157, v79, v75, s68
s_waitcnt vmcnt(3)
v_perm_b32 v130, v84, v80, s67
v_perm_b32 v134, v84, v80, s68
v_perm_b32 v138, v85, v81, s67
v_perm_b32 v142, v85, v81, s68
v_perm_b32 v146, v86, v82, s67
v_perm_b32 v150, v86, v82, s68
v_perm_b32 v154, v87, v83, s67
v_perm_b32 v158, v87, v83, s68
s_waitcnt vmcnt(1)
v_perm_b32 v131, v92, v88, s67
v_perm_b32 v135, v92, v88, s68
v_perm_b32 v139, v93, v89, s67
v_perm_b32 v143, v93, v89, s68
v_perm_b32 v147, v94, v90, s67
v_perm_b32 v151, v94, v90, s68
v_perm_b32 v155, v95, v91, s67
v_perm_b32 v159, v95, v91, s68
s_waitcnt vmcnt(0)
s_branch pchk_33
poll_31:
buffer_load_dwordx2 v[32:33], v21, s[40:43], s60 offen offset:0 sc1
s_waitcnt vmcnt(0)
pchk_33:
v_xor_b32 v32, v252, v32
v_xor_b32 v33, v253, v33
v_or_b32 v28, v32, v33
v_and_b32 v28, 15, v28
v_cmp_ne_u32 vcc, 0, v28
s_cbranch_vccz pdone_32
s_add_u32 s64, s64, 1
s_cmp_lt_u32 s64, 1000000
s_cbranch_scc1 poll_31
pdone_32:
v_permlane16_swap_b32 v32, v33
v_add_f32 v32, v32, v33
v_mov_b32 v33, v32
s_nop 1
v_permlane32_swap_b32 v32, v33
v_add_f32 v24, v32, v33
v_cvt_pk_bf16_f32 v24, v24, v24
v_and_b32 v24, 0xffff0000, v24
v_mul_f32 v34, 0xbfb8aa3b, v24
v_exp_f32 v34, v34
s_nop 0
v_add_f32 v34, 1.0, v34
v_min_f32 v34, 0x7f000000, v34
v_rcp_f32 v35, v34
s_nop 0
v_mul_f32 v36, v24, v35
v_fma_f32 v24, -v36, v34, v24
v_fma_f32 v24, v24, v35, v36
v_cvt_pk_bf16_f32 v24, v24, v24
ds_write_b16 v22, v24
ds_read_b128 v[16:19], v7
s_waitcnt lgkmcnt(0)
v_mfma_f32_16x16x32_bf16 v[32:35], v[16:19], v[128:131], 0
v_mfma_f32_16x16x32_bf16 v[36:39], v[16:19], v[132:135], 0
v_mfma_f32_16x16x32_bf16 v[40:43], v[16:19], v[136:139], 0
v_mfma_f32_16x16x32_bf16 v[44:47], v[16:19], v[140:143], 0
v_mfma_f32_16x16x32_bf16 v[48:51], v[16:19], v[144:147], 0
v_mfma_f32_16x16x32_bf16 v[52:55], v[16:19], v[148:151], 0
v_mfma_f32_16x16x32_bf16 v[56:59], v[16:19], v[152:155], 0
v_mfma_f32_16x16x32_bf16 v[60:63], v[16:19], v[156:159], 0
s_nop 0
v_mov_b32_dpp v28, v32 quad_perm:[0,1,2,3] row_mask:0x1 bank_mask:0xf
v_mov_b32_dpp v29, v36 quad_perm:[0,1,2,3] row_mask:0x1 bank_mask:0xf
v_mov_b32_dpp v28, v40 quad_perm:[0,1,2,3] row_mask:0x2 bank_mask:0xf
v_mov_b32_dpp v29, v44 quad_perm:[0,1,2,3] row_mask:0x2 bank_mask:0xf
v_mov_b32_dpp v28, v48 quad_perm:[0,1,2,3] row_mask:0x4 bank_mask:0xf
v_mov_b32_dpp v29, v52 quad_perm:[0,1,2,3] row_mask:0x4 bank_mask:0xf
v_mov_b32_dpp v28, v56 quad_perm:[0,1,2,3] row_mask:0x8 bank_mask:0xf
v_mov_b32_dpp v29, v60 quad_perm:[0,1,2,3] row_mask:0x8 bank_mask:0xf
ds_write_b64 v8, v[28:29]
s_lshr_b32 s50, s3, 1
s_waitcnt lgkmcnt(0)
s_barrier
s_cmp_lg_u32 s50, 3
s_cbranch_scc1 sk_34
ds_read2st64_b32 v[48:49], v6 offset0:4 offset1:6
ds_read2st64_b32 v[50:51], v6 offset0:8 offset1:10
ds_read2st64_b32 v[52:53], v6 offset0:12 offset1:14
ds_read2st64_b32 v[54:55], v6 offset0:16 offset1:18
s_waitcnt lgkmcnt(2)
v_add_f32 v48, v48, v49
v_add_f32 v50, v50, v51
s_waitcnt lgkmcnt(0)
v_add_f32 v52, v52, v53
v_add_f32 v54, v54, v55
v_add_f32 v48, v48, v50
v_add_f32 v52, v52, v54
v_add_f32 v48, v48, v52
v_add_u32 v48, 8, v48
v_and_or_b32 v48, v48, s69, v11
buffer_store_dword v48, v6, s[40:43], s61 offen
s_cmp_eq_u32 s65, 1
s_cbranch_scc1 sk_35
buffer_store_dword v48, v6, s[40:43], s61 offen sc1
sk_35:
sk_34:
s_branch L_exit
L_leader:
s_cmp_eq_u32 s3, 3
s_cbranch_scc1 L_lead5
s_cmp_ge_u32 s3, 6
s_cbranch_scc1 L_lead6
s_cmp_lg_u32 s3, 4
s_cbranch_scc1 L_exit
s_lshr_b32 s51, s63, 1
s_lshl_b32 s51, s51, 13
s_and_b32 s50, s63, 1
s_lshl_b32 s50, s50, 8
s_add_u32 s51, s51, s50
s_add_u32 s6, s51, 0x50000
s_add_u32 s7, s6, 4096
s_add_u32 s10, s51, 0xb0000
s_add_u32 s11, s10, 4096
s_lshl_b32 s52, s63, 8
s_add_u32 s52, s52, 0x36000
s_mov_b32 s44, s24
s_mov_b32 s45, s25
s_mov_b32 s46, 0x800
s_mov_b32 s47, 0x20000
s_mov_b32 s64, 0
poll_36:
buffer_load_dwordx4 v[176:179], v14, s[40:43], s10 offen offset:0 sc1
buffer_load_dwordx4 v[180:183], v14, s[40:43], s10 offen offset:2048 sc1
buffer_load_dwordx4 v[184:187], v14, s[40:43], s11 offen offset:0 sc1
buffer_load_dwordx4 v[188:191], v14, s[40:43], s11 offen offset:2048 sc1
buffer_load_dword v27, v22, s[40:43], s52 offen offset:0 sc1
s_waitcnt vmcnt(0)
pchk_38:
v_xor_b32 v176, v248, v176
v_xor_b32 v177, v249, v177
v_xor_b32 v178, v250, v178
v_xor_b32 v179, v251, v179
v_xor_b32 v180, v248, v180
v_xor_b32 v181, v249, v181
v_xor_b32 v182, v250, v182
v_xor_b32 v183, v251, v183
v_xor_b32 v184, v248, v184
v_xor_b32 v185, v249, v185
v_xor_b32 v186, v250, v186
v_xor_b32 v187, v251, v187
v_xor_b32 v188, v248, v188
v_xor_b32 v189, v249, v189
v_xor_b32 v190, v250, v190
v_xor_b32 v191, v251, v191
v_xor_b32 v27, v26, v27
v_or3_b32 v28, v176, v177, v178
v_or3_b32 v28, v28, v179, v180
v_or3_b32 v28, v28, v181, v182
v_or3_b32 v28, v28, v183, v184
v_or3_b32 v28, v28, v185, v186
v_or3_b32 v28, v28, v187, v188
v_or3_b32 v28, v28, v189, v190
v_or3_b32 v28, v28, v191, v27
v_and_b32 v28, 15, v28
v_cmp_ne_u32 vcc, 0, v28
s_cbranch_vccz pdone_37
s_sleep 2
s_add_u32 s64, s64, 1
s_cmp_lt_u32 s64, 1000000
s_cbranch_scc1 poll_36
pdone_37:
v_add_f32 v176, v176, v180
v_add_f32 v177, v177, v181
v_add_f32 v178, v178, v182
v_add_f32 v179, v179, v183
v_add_f32 v184, v184, v188
v_add_f32 v185, v185, v189
v_add_f32 v186, v186, v190
v_add_f32 v187, v187, v191
v_add_f32 v176, v176, v184
v_add_f32 v177, v177, v185
v_add_f32 v178, v178, v186
v_add_f32 v179, v179, v187
s_nop 0
v_permlane16_swap_b32 v176, v177
v_permlane16_swap_b32 v178, v179
v_add_f32 v176, v176, v177
v_add_f32 v178, v178, v179
s_nop 1
v_permlane32_swap_b32 v176, v178
v_add_f32 v176, v176, v178
v_cvt_pk_bf16_f32 v176, v176, v176
v_and_b32 v176, 0xffff0000, v176
s_lshl_b32 s52, s63, 7
s_mov_b32 s64, 0
poll_39:
buffer_load_dwordx4 v[32:35], v14, s[40:43], s6 offen offset:0 sc1
buffer_load_dwordx4 v[36:39], v14, s[40:43], s6 offen offset:2048 sc1
buffer_load_dwordx4 v[40:43], v14, s[40:43], s7 offen offset:0 sc1
buffer_load_dwordx4 v[44:47], v15, s[40:43], s7 offen offset:2048 sc1
s_waitcnt vmcnt(0)
pchk_41:
v_xor_b32 v32, v248, v32
v_xor_b32 v33, v249, v33
v_xor_b32 v34, v250, v34
v_xor_b32 v35, v251, v35
v_xor_b32 v36, v248, v36
v_xor_b32 v37, v249, v37
v_xor_b32 v38, v250, v38
v_xor_b32 v39, v251, v39
v_xor_b32 v40, v248, v40
v_xor_b32 v41, v249, v41
v_xor_b32 v42, v250, v42
v_xor_b32 v43, v251, v43
v_xor_b32 v44, v248, v44
v_xor_b32 v45, v249, v45
v_xor_b32 v46, v250, v46
v_xor_b32 v47, v251, v47
v_or3_b32 v28, v32, v33, v34
v_or3_b32 v28, v28, v35, v36
v_or3_b32 v28, v28, v37, v38
v_or3_b32 v28, v28, v39, v40
v_or3_b32 v28, v28, v41, v42
v_or3_b32 v28, v28, v43, v44
v_or3_b32 v28, v28, v45, v46
v_or_b32 v28, v28, v47
v_and_b32 v28, 15, v28
v_cmp_ne_u32 vcc, 0, v28
s_cbranch_vccz pdone_40
s_add_u32 s64, s64, 1
s_cmp_lt_u32 s64, 1000000
s_cbranch_scc1 poll_39
pdone_40:
s_mov_b64 exec, 0xffffffff
v_add_f32 v40, v40, v44
v_add_f32 v41, v41, v45
v_add_f32 v42, v42, v46
v_add_f32 v43, v43, v47
s_mov_b64 exec, -1
v_add_f32 v32, v32, v36
v_add_f32 v33, v33, v37
v_add_f32 v34, v34, v38
v_add_f32 v35, v35, v39
v_add_f32 v32, v32, v40
v_add_f32 v33, v33, v41
v_add_f32 v34, v34, v42
v_add_f32 v35, v35, v43
s_nop 0
v_permlane16_swap_b32 v32, v33
v_permlane16_swap_b32 v34, v35
v_add_f32 v32, v32, v33
v_add_f32 v34, v34, v35
s_nop 1
v_permlane32_swap_b32 v32, v34
v_add_f32 v32, v32, v34
v_cvt_pk_bf16_f32 v32, v32, v32
v_and_b32 v32, 0xffff0000, v32
v_mul_f32 v32, v32, v176
v_cvt_pk_bf16_f32 v32, v32, v32
v_and_b32 v32, 0xffff0000, v32
v_add_f32 v27, v27, v32
v_cvt_pk_bf16_f32 v27, v27, v27
buffer_store_short v27, v23, s[44:47], s52 offen
s_cmp_lg_u32 s63, 0
s_cbranch_scc1 L_exit
s_mov_b64 exec, 1
v_mov_b32 v36, 0
v_mov_b32 v37, s31
buffer_store_dword v37, v36, s[40:43], 0 offen sc1
s_branch L_exit
L_lead6:
s_lshl_b32 s52, s63, 1
s_add_u32 s52, s52, s3
s_sub_u32 s52, s52, 6
s_cmp_ge_u32 s52, 28
s_cbranch_scc1 L_exit
s_and_b32 s48, s52, 3
s_and_b32 s49, s52, 28
s_add_u32 s49, s49, 1
L_lead5:
s_lshr_b32 s53, s49, 1
s_lshl_b32 s55, s48, 1
s_and_b32 s50, s49, 1
s_add_u32 s55, s55, s50
s_xor_b32 s55, s55, 1
s_mul_i32 s54, s53, 786432
s_lshl_b32 s50, s55, 8
s_add_u32 s54, s54, s50
s_add_u32 s54, s54, 10240
s_lshl_b32 s56, s55, 4
s_add_u32 s56, s56, s53
s_lshl_b32 s56, s56, 9
s_add_u32 s56, s56, 0xb0000
buffer_load_dwordx4 v[96:99], v13, s[36:39], s54 offen nt
s_add_u32 s50, s54, 0x3000
buffer_load_dwordx4 v[100:103], v13, s[36:39], s50 offen nt
s_add_u32 s50, s54, 0x6000
buffer_load_dwordx4 v[104:107], v13, s[36:39], s50 offen nt
s_add_u32 s50, s54, 0x9000
buffer_load_dwordx4 v[108:111], v13, s[36:39], s50 offen nt
s_add_u32 s50, s54, 0xc000
buffer_load_dwordx4 v[112:115], v13, s[36:39], s50 offen nt
s_add_u32 s50, s54, 0xf000
buffer_load_dwordx4 v[116:119], v13, s[36:39], s50 offen nt
s_add_u32 s50, s54, 0x12000
buffer_load_dwordx4 v[120:123], v13, s[36:39], s50 offen nt
s_add_u32 s50, s54, 0x15000
buffer_load_dwordx4 v[124:127], v13, s[36:39], s50 offen nt
s_add_u32 s50, s54, 0x60000
buffer_load_dwordx4 v[160:163], v13, s[36:39], s50 offen nt
s_add_u32 s50, s54, 0x63000
buffer_load_dwordx4 v[164:167], v13, s[36:39], s50 offen nt
s_add_u32 s50, s54, 0x66000
buffer_load_dwordx4 v[168:171], v13, s[36:39], s50 offen nt
s_add_u32 s50, s54, 0x69000
buffer_load_dwordx4 v[172:175], v13, s[36:39], s50 offen nt
s_add_u32 s50, s54, 0x6c000
buffer_load_dwordx4 v[176:179], v13, s[36:39], s50 offen nt
s_add_u32 s50, s54, 0x6f000
buffer_load_dwordx4 v[180:183], v13, s[36:39], s50 offen nt
s_add_u32 s50, s54, 0x72000
buffer_load_dwordx4 v[184:187], v13, s[36:39], s50 offen nt
s_add_u32 s50, s54, 0x75000
buffer_load_dwordx4 v[188:191], v13, s[36:39], s50 offen nt
s_lshr_b32 s50, s49, 1
s_lshl_b32 s50, s50, 7
s_load_dwordx16 s[4:19], s[20:21], s50
s_waitcnt lgkmcnt(0)
s_mov_b32 exec_lo, 0xffff
s_mov_b32 exec_hi, 0x0
v_mov_b32 v224, s4
v_mov_b32 v225, s5
v_mov_b32 v226, s6
v_mov_b32 v227, s7
s_mov_b32 exec_lo, 0xffff0000
s_mov_b32 exec_hi, 0x0
v_mov_b32 v224, s8
v_mov_b32 v225, s9
v_mov_b32 v226, s10
v_mov_b32 v227, s11
s_mov_b32 exec_lo, 0x0
s_mov_b32 exec_hi, 0xffff
v_mov_b32 v224, s12
v_mov_b32 v225, s13
v_mov_b32 v226, s14
v_mov_b32 v227, s15
s_mov_b32 exec_lo, 0x0
s_mov_b32 exec_hi, 0xffff0000
v_mov_b32 v224, s16
v_mov_b32 v225, s17
v_mov_b32 v226, s18
v_mov_b32 v227, s19
s_mov_b64 exec, -1
s_add_u32 s50, s50, 64
s_load_dwordx16 s[4:19], s[20:21], s50
s_waitcnt lgkmcnt(0)
s_mov_b32 exec_lo, 0xffff
s_mov_b32 exec_hi, 0x0
v_mov_b32 v228, s4
v_mov_b32 v229, s5
v_mov_b32 v230, s6
v_mov_b32 v231, s7
s_mov_b32 exec_lo, 0xffff0000
s_mov_b32 exec_hi, 0x0
v_mov_b32 v228, s8
v_mov_b32 v229, s9
v_mov_b32 v230, s10
v_mov_b32 v231, s11
s_mov_b32 exec_lo, 0x0
s_mov_b32 exec_hi, 0xffff
v_mov_b32 v228, s12
v_mov_b32 v229, s13
v_mov_b32 v230, s14
v_mov_b32 v231, s15
s_mov_b32 exec_lo, 0x0
s_mov_b32 exec_hi, 0xffff0000
v_mov_b32 v228, s16
v_mov_b32 v229, s17
v_mov_b32 v230, s18
v_mov_b32 v231, s19
s_mov_b64 exec, -1
s_load_dwordx16 s[4:19], s[0:1], 0
v_lshlrev_b32 v32, 16, v224
v_and_b32 v33, 0xffff0000, v224
v_lshlrev_b32 v34, 16, v225
v_and_b32 v35, 0xffff0000, v225
v_mul_f32 v36, 0xbfb8aa3b, v32
v_mul_f32 v37, 0xbfb8aa3b, v33
v_mul_f32 v38, 0xbfb8aa3b, v34
v_mul_f32 v39, 0xbfb8aa3b, v35
v_exp_f32 v36, v36
v_exp_f32 v37, v37
v_exp_f32 v38, v38
v_exp_f32 v39, v39
v_add_f32 v36, 1.0, v36
v_add_f32 v37, 1.0, v37
v_add_f32 v38, 1.0, v38
v_add_f32 v39, 1.0, v39
v_min_f32 v36, 0x7f000000, v36
v_min_f32 v37, 0x7f000000, v37
v_min_f32 v38, 0x7f000000, v38
v_min_f32 v39, 0x7f000000, v39
v_rcp_f32 v40, v36
v_rcp_f32 v41, v37
v_rcp_f32 v42, v38
v_rcp_f32 v43, v39
v_mul_f32 v44, v32, v40
v_mul_f32 v45, v33, v41
v_mul_f32 v46, v34, v42
v_mul_f32 v47, v35, v43
v_fma_f32 v32, -v44, v36, v32
v_fma_f32 v33, -v45, v37, v33
v_fma_f32 v34, -v46, v38, v34
v_fma_f32 v35, -v47, v39, v35
v_fma_f32 v32, v32, v40, v44
v_fma_f32 v33, v33, v41, v45
v_fma_f32 v34, v34, v42, v46
v_fma_f32 v35, v35, v43, v47
v_cvt_pk_bf16_f32 v224, v32, v33
v_cvt_pk_bf16_f32 v225, v34, v35
v_lshlrev_b32 v32, 16, v226
v_and_b32 v33, 0xffff0000, v226
v_lshlrev_b32 v34, 16, v227
v_and_b32 v35, 0xffff0000, v227
v_mul_f32 v36, 0xbfb8aa3b, v32
v_mul_f32 v37, 0xbfb8aa3b, v33
v_mul_f32 v38, 0xbfb8aa3b, v34
v_mul_f32 v39, 0xbfb8aa3b, v35
v_exp_f32 v36, v36
v_exp_f32 v37, v37
v_exp_f32 v38, v38
v_exp_f32 v39, v39
v_add_f32 v36, 1.0, v36
v_add_f32 v37, 1.0, v37
v_add_f32 v38, 1.0, v38
v_add_f32 v39, 1.0, v39
v_min_f32 v36, 0x7f000000, v36
v_min_f32 v37, 0x7f000000, v37
v_min_f32 v38, 0x7f000000, v38
v_min_f32 v39, 0x7f000000, v39
v_rcp_f32 v40, v36
v_rcp_f32 v41, v37
v_rcp_f32 v42, v38
v_rcp_f32 v43, v39
v_mul_f32 v44, v32, v40
v_mul_f32 v45, v33, v41
v_mul_f32 v46, v34, v42
v_mul_f32 v47, v35, v43
v_fma_f32 v32, -v44, v36, v32
v_fma_f32 v33, -v45, v37, v33
v_fma_f32 v34, -v46, v38, v34
v_fma_f32 v35, -v47, v39, v35
v_fma_f32 v32, v32, v40, v44
v_fma_f32 v33, v33, v41, v45
v_fma_f32 v34, v34, v42, v46
v_fma_f32 v35, v35, v43, v47
v_cvt_pk_bf16_f32 v226, v32, v33
v_cvt_pk_bf16_f32 v227, v34, v35
v_lshlrev_b32 v32, 16, v228
v_and_b32 v33, 0xffff0000, v228
v_lshlrev_b32 v34, 16, v229
v_and_b32 v35, 0xffff0000, v229
v_mul_f32 v36, 0xbfb8aa3b, v32
v_mul_f32 v37, 0xbfb8aa3b, v33
v_mul_f32 v38, 0xbfb8aa3b, v34
v_mul_f32 v39, 0xbfb8aa3b, v35
v_exp_f32 v36, v36
v_exp_f32 v37, v37
v_exp_f32 v38, v38
v_exp_f32 v39, v39
v_add_f32 v36, 1.0, v36
v_add_f32 v37, 1.0, v37
v_add_f32 v38, 1.0, v38
v_add_f32 v39, 1.0, v39
v_min_f32 v36, 0x7f000000, v36
v_min_f32 v37, 0x7f000000, v37
v_min_f32 v38, 0x7f000000, v38
v_min_f32 v39, 0x7f000000, v39
v_rcp_f32 v40, v36
v_rcp_f32 v41, v37
v_rcp_f32 v42, v38
v_rcp_f32 v43, v39
v_mul_f32 v44, v32, v40
v_mul_f32 v45, v33, v41
v_mul_f32 v46, v34, v42
v_mul_f32 v47, v35, v43
v_fma_f32 v32, -v44, v36, v32
v_fma_f32 v33, -v45, v37, v33
v_fma_f32 v34, -v46, v38, v34
v_fma_f32 v35, -v47, v39, v35
v_fma_f32 v32, v32, v40, v44
v_fma_f32 v33, v33, v41, v45
v_fma_f32 v34, v34, v42, v46
v_fma_f32 v35, v35, v43, v47
v_cvt_pk_bf16_f32 v228, v32, v33
v_cvt_pk_bf16_f32 v229, v34, v35
v_lshlrev_b32 v32, 16, v230
v_and_b32 v33, 0xffff0000, v230
v_lshlrev_b32 v34, 16, v231
v_and_b32 v35, 0xffff0000, v231
v_mul_f32 v36, 0xbfb8aa3b, v32
v_mul_f32 v37, 0xbfb8aa3b, v33
v_mul_f32 v38, 0xbfb8aa3b, v34
v_mul_f32 v39, 0xbfb8aa3b, v35
v_exp_f32 v36, v36
v_exp_f32 v37, v37
v_exp_f32 v38, v38
v_exp_f32 v39, v39
v_add_f32 v36, 1.0, v36
v_add_f32 v37, 1.0, v37
v_add_f32 v38, 1.0, v38
v_add_f32 v39, 1.0, v39
v_min_f32 v36, 0x7f000000, v36
v_min_f32 v37, 0x7f000000, v37
v_min_f32 v38, 0x7f000000, v38
v_min_f32 v39, 0x7f000000, v39
v_rcp_f32 v40, v36
v_rcp_f32 v41, v37
v_rcp_f32 v42, v38
v_rcp_f32 v43, v39
v_mul_f32 v44, v32, v40
v_mul_f32 v45, v33, v41
v_mul_f32 v46, v34, v42
v_mul_f32 v47, v35, v43
v_fma_f32 v32, -v44, v36, v32
v_fma_f32 v33, -v45, v37, v33
v_fma_f32 v34, -v46, v38, v34
v_fma_f32 v35, -v47, v39, v35
v_fma_f32 v32, v32, v40, v44
v_fma_f32 v33, v33, v41, v45
v_fma_f32 v34, v34, v42, v46
v_fma_f32 v35, v35, v43, v47
v_cvt_pk_bf16_f32 v230, v32, v33
v_cvt_pk_bf16_f32 v231, v34, v35
s_waitcnt lgkmcnt(0)
s_waitcnt vmcnt(8)
v_perm_b32 v192, v100, v96, s67
v_perm_b32 v196, v100, v96, s68
v_perm_b32 v200, v101, v97, s67
v_perm_b32 v204, v101, v97, s68
v_perm_b32 v208, v102, v98, s67
v_perm_b32 v212, v102, v98, s68
v_perm_b32 v216, v103, v99, s67
v_perm_b32 v220, v103, v99, s68
v_perm_b32 v193, v108, v104, s67
v_perm_b32 v197, v108, v104, s68
v_perm_b32 v201, v109, v105, s67
v_perm_b32 v205, v109, v105, s68
v_perm_b32 v209, v110, v106, s67
v_perm_b32 v213, v110, v106, s68
v_perm_b32 v217, v111, v107, s67
v_perm_b32 v221, v111, v107, s68
v_perm_b32 v194, v116, v112, s67
v_perm_b32 v198, v116, v112, s68
v_perm_b32 v202, v117, v113, s67
v_perm_b32 v206, v117, v113, s68
v_perm_b32 v210, v118, v114, s67
v_perm_b32 v214, v118, v114, s68
v_perm_b32 v218, v119, v115, s67
v_perm_b32 v222, v119, v115, s68
v_perm_b32 v195, v124, v120, s67
v_perm_b32 v199, v124, v120, s68
v_perm_b32 v203, v125, v121, s67
v_perm_b32 v207, v125, v121, s68
v_perm_b32 v211, v126, v122, s67
v_perm_b32 v215, v126, v122, s68
v_perm_b32 v219, v127, v123, s67
v_perm_b32 v223, v127, v123, s68
v_mfma_f32_16x16x32_bf16 v[32:35], v[224:227], v[192:195], 0
v_mfma_f32_16x16x32_bf16 v[36:39], v[224:227], v[196:199], 0
v_mfma_f32_16x16x32_bf16 v[40:43], v[224:227], v[200:203], 0
v_mfma_f32_16x16x32_bf16 v[44:47], v[224:227], v[204:207], 0
v_mfma_f32_16x16x32_bf16 v[48:51], v[224:227], v[208:211], 0
v_mfma_f32_16x16x32_bf16 v[52:55], v[224:227], v[212:215], 0
v_mfma_f32_16x16x32_bf16 v[56:59], v[224:227], v[216:219], 0
v_mfma_f32_16x16x32_bf16 v[60:63], v[224:227], v[220:223], 0
s_waitcnt vmcnt(0)
v_perm_b32 v96, v164, v160, s67
v_perm_b32 v100, v164, v160, s68
v_perm_b32 v104, v165, v161, s67
v_perm_b32 v108, v165, v161, s68
v_perm_b32 v112, v166, v162, s67
v_perm_b32 v116, v166, v162, s68
v_perm_b32 v120, v167, v163, s67
v_perm_b32 v124, v167, v163, s68
v_perm_b32 v97, v172, v168, s67
v_perm_b32 v101, v172, v168, s68
v_perm_b32 v105, v173, v169, s67
v_perm_b32 v109, v173, v169, s68
v_perm_b32 v113, v174, v170, s67
v_perm_b32 v117, v174, v170, s68
v_perm_b32 v121, v175, v171, s67
v_perm_b32 v125, v175, v171, s68
v_perm_b32 v98, v180, v176, s67
v_perm_b32 v102, v180, v176, s68
v_perm_b32 v106, v181, v177, s67
v_perm_b32 v110, v181, v177, s68
v_perm_b32 v114, v182, v178, s67
v_perm_b32 v118, v182, v178, s68
v_perm_b32 v122, v183, v179, s67
v_perm_b32 v126, v183, v179, s68
v_perm_b32 v99, v188, v184, s67
v_perm_b32 v103, v188, v184, s68
v_perm_b32 v107, v189, v185, s67
v_perm_b32 v111, v189, v185, s68
v_perm_b32 v115, v190, v186, s67
v_perm_b32 v119, v190, v186, s68
v_perm_b32 v123, v191, v187, s67
v_perm_b32 v127, v191, v187, s68
v_mfma_f32_16x16x32_bf16 v[32:35], v[228:231], v[96:99], v[32:35]
v_mfma_f32_16x16x32_bf16 v[36:39], v[228:231], v[100:103], v[36:39]
v_mfma_f32_16x16x32_bf16 v[40:43], v[228:231], v[104:107], v[40:43]
v_mfma_f32_16x16x32_bf16 v[44:47], v[228:231], v[108:111], v[44:47]
v_mfma_f32_16x16x32_bf16 v[48:51], v[228:231], v[112:115], v[48:51]
v_mfma_f32_16x16x32_bf16 v[52:55], v[228:231], v[116:119], v[52:55]
v_mfma_f32_16x16x32_bf16 v[56:59], v[228:231], v[120:123], v[56:59]
v_mfma_f32_16x16x32_bf16 v[60:63], v[228:231], v[124:127], v[60:63]
v_lshlrev_b32 v30, 3, v3
v_lshrrev_b32 v30, v30, s31
v_bfe_u32 v31, v30, 4, 4
v_and_b32 v30, 15, v30
s_nop 0
v_mov_b32_dpp v28, v32 quad_perm:[0,1,2,3] row_mask:0x1 bank_mask:0xf
v_mov_b32_dpp v29, v36 quad_perm:[0,1,2,3] row_mask:0x1 bank_mask:0xf
v_mov_b32_dpp v28, v40 quad_perm:[0,1,2,3] row_mask:0x2 bank_mask:0xf
v_mov_b32_dpp v29, v44 quad_perm:[0,1,2,3] row_mask:0x2 bank_mask:0xf
v_mov_b32_dpp v28, v48 quad_perm:[0,1,2,3] row_mask:0x4 bank_mask:0xf
v_mov_b32_dpp v29, v52 quad_perm:[0,1,2,3] row_mask:0x4 bank_mask:0xf
v_mov_b32_dpp v28, v56 quad_perm:[0,1,2,3] row_mask:0x8 bank_mask:0xf
v_mov_b32_dpp v29, v60 quad_perm:[0,1,2,3] row_mask:0x8 bank_mask:0xf
v_add_u32 v28, 8, v28
v_and_or_b32 v28, v28, s69, v30
v_add_u32 v29, 8, v29
v_and_or_b32 v29, v29, s69, v31
buffer_store_dwordx2 v[28:29], v5, s[40:43], s56 offen sc1
s_branch L_exit
L_pclass:
L_p_h2:
s_barrier
s_getreg_b32 s66, hwreg(HW_REG_XCC_ID, 0, 4)
s_mov_b32 s67, 0x05040100
s_mov_b32 s68, 0x07060302
s_mov_b32 s69, 0xfffffff0
s_mov_b32 s65, 0
v_lshlrev_b32 v4, 4, v3
v_lshlrev_b32 v5, 1, v2
v_lshl_add_u32 v5, v3, 3, v5
s_lshl_b32 s50, s3, 9
s_add_u32 s50, s50, 0x400
v_add_u32 v8, s50, v5
v_lshlrev_b32 v9, 2, v1
s_and_b32 s50, s3, 1
s_lshl_b32 s50, s50, 8
v_add_u32 v6, s50, v9
s_lshl_b32 s50, s3, 6
s_add_u32 s50, s50, 0x200
v_add_u32 v7, s50, v4
v_lshlrev_b32 v10, 3, v1
s_mov_b32 s40, s28
s_mov_b32 s41, s29
s_mov_b32 s42, 0x10000000
s_mov_b32 s43, 0x20000
s_lshl_b32 s61, s61, 2
s_add_u32 s61, s61, s62
s_lshl_b32 s61, s61, 9
s_add_u32 s61, s61, 0x20000
s_lshr_b32 s59, s49, 2
s_lshl_b32 s59, s59, 2
s_add_u32 s59, s59, s3
s_mul_i32 s58, s59, 393216
s_bfe_u32 s62, s49, 0x10001
s_lshl_b32 s62, s62, 3
s_lshl_b32 s50, s48, 1
s_add_u32 s62, s62, s50
s_and_b32 s50, s49, 1
s_xor_b32 s50, s50, 1
s_add_u32 s62, s62, s50
s_lshl_b32 s50, s62, 8
s_add_u32 s58, s58, s50
s_add_u32 s58, s58, 6144
s_lshl_b32 s62, s62, 3
s_lshr_b32 s50, s49, 2
s_add_u32 s62, s62, s50
s_lshl_b32 s62, s62, 9
s_add_u32 s62, s62, 0xc0000
s_lshl_b32 s59, s59, 6
s_mov_b32 s36, s22
s_mov_b32 s37, s23
s_mov_b32 s38, 0xc00000
s_mov_b32 s39, 0x20000
s_load_dwordx16 s[4:19], s[20:21], s59
s_waitcnt lgkmcnt(0)
s_mov_b32 exec_lo, 0xffff
s_mov_b32 exec_hi, 0x0
v_mov_b32 v240, s4
v_mov_b32 v241, s5
v_mov_b32 v242, s6
v_mov_b32 v243, s7
s_mov_b32 exec_lo, 0xffff0000
s_mov_b32 exec_hi, 0x0
v_mov_b32 v240, s8
v_mov_b32 v241, s9
v_mov_b32 v242, s10
v_mov_b32 v243, s11
s_mov_b32 exec_lo, 0x0
s_mov_b32 exec_hi, 0xffff
v_mov_b32 v240, s12
v_mov_b32 v241, s13
v_mov_b32 v242, s14
v_mov_b32 v243, s15
s_mov_b32 exec_lo, 0x0
s_mov_b32 exec_hi, 0xffff0000
v_mov_b32 v240, s16
v_mov_b32 v241, s17
v_mov_b32 v242, s18
v_mov_b32 v243, s19
s_mov_b64 exec, -1
s_load_dwordx16 s[4:19], s[0:1], 0
v_lshlrev_b32 v200, 16, v240
v_and_b32 v201, 0xffff0000, v240
v_lshlrev_b32 v202, 16, v241
v_and_b32 v203, 0xffff0000, v241
v_mul_f32 v204, 0xbfb8aa3b, v200
v_mul_f32 v205, 0xbfb8aa3b, v201
v_mul_f32 v206, 0xbfb8aa3b, v202
v_mul_f32 v207, 0xbfb8aa3b, v203
v_exp_f32 v204, v204
v_exp_f32 v205, v205
v_exp_f32 v206, v206
v_exp_f32 v207, v207
v_add_f32 v204, 1.0, v204
v_add_f32 v205, 1.0, v205
v_add_f32 v206, 1.0, v206
v_add_f32 v207, 1.0, v207
v_min_f32 v204, 0x7f000000, v204
v_min_f32 v205, 0x7f000000, v205
v_min_f32 v206, 0x7f000000, v206
v_min_f32 v207, 0x7f000000, v207
v_rcp_f32 v208, v204
v_rcp_f32 v209, v205
v_rcp_f32 v210, v206
v_rcp_f32 v211, v207
v_mul_f32 v212, v200, v208
v_mul_f32 v213, v201, v209
v_mul_f32 v214, v202, v210
v_mul_f32 v215, v203, v211
v_fma_f32 v200, -v212, v204, v200
v_fma_f32 v201, -v213, v205, v201
v_fma_f32 v202, -v214, v206, v202
v_fma_f32 v203, -v215, v207, v203
v_fma_f32 v200, v200, v208, v212
v_fma_f32 v201, v201, v209, v213
v_fma_f32 v202, v202, v210, v214
v_fma_f32 v203, v203, v211, v215
v_cvt_pk_bf16_f32 v240, v200, v201
v_cvt_pk_bf16_f32 v241, v202, v203
v_lshlrev_b32 v200, 16, v242
v_and_b32 v201, 0xffff0000, v242
v_lshlrev_b32 v202, 16, v243
v_and_b32 v203, 0xffff0000, v243
v_mul_f32 v204, 0xbfb8aa3b, v200
v_mul_f32 v205, 0xbfb8aa3b, v201
v_mul_f32 v206, 0xbfb8aa3b, v202
v_mul_f32 v207, 0xbfb8aa3b, v203
v_exp_f32 v204, v204
v_exp_f32 v205, v205
v_exp_f32 v206, v206
v_exp_f32 v207, v207
v_add_f32 v204, 1.0, v204
v_add_f32 v205, 1.0, v205
v_add_f32 v206, 1.0, v206
v_add_f32 v207, 1.0, v207
v_min_f32 v204, 0x7f000000, v204
v_min_f32 v205, 0x7f000000, v205
v_min_f32 v206, 0x7f000000, v206
v_min_f32 v207, 0x7f000000, v207
v_rcp_f32 v208, v204
v_rcp_f32 v209, v205
v_rcp_f32 v210, v206
v_rcp_f32 v211, v207
v_mul_f32 v212, v200, v208
v_mul_f32 v213, v201, v209
v_mul_f32 v214, v202, v210
v_mul_f32 v215, v203, v211
v_fma_f32 v200, -v212, v204, v200
v_fma_f32 v201, -v213, v205, v201
v_fma_f32 v202, -v214, v206, v202
v_fma_f32 v203, -v215, v207, v203
v_fma_f32 v200, v200, v208, v212
v_fma_f32 v201, v201, v209, v213
v_fma_f32 v202, v202, v210, v214
v_fma_f32 v203, v203, v211, v215
v_cvt_pk_bf16_f32 v242, v200, v201
v_cvt_pk_bf16_f32 v243, v202, v203
s_waitcnt lgkmcnt(0)
s_add_u32 s31, s30, 0x9e3779b9
s_mul_i32 s31, s31, 0x85ebca6b
s_lshr_b32 s50, s31, 15
s_xor_b32 s31, s31, s50
s_mul_i32 s31, s31, 0xc2b2ae35
s_lshr_b32 s50, s31, 13
s_xor_b32 s31, s31, s50
s_or_b32 s31, s31, 0x11111111
s_xor_b32 s31, s31, s30
v_and_b32 v11, 7, v1
v_lshlrev_b32 v11, 2, v11
v_bfe_u32 v11, s31, v11, 4
v_and_b32 v251, 1, v1
v_lshlrev_b32 v251, 4, v251
v_lshrrev_b32 v251, v251, s31
v_bfe_u32 v248, v251, 0, 4
v_bfe_u32 v249, v251, 4, 4
v_bfe_u32 v250, v251, 8, 4
v_bfe_u32 v251, v251, 12, 4
v_and_b32 v253, 3, v1
v_lshlrev_b32 v253, 3, v253
v_lshrrev_b32 v253, v253, s31
v_bfe_u32 v252, v253, 0, 4
v_bfe_u32 v253, v253, 4, 4
s_mov_b32 s50, 98304
v_mul_lo_u32 v13, v3, s50
v_add_u32 v13, v13, v2
s_waitcnt vmcnt(8)
v_perm_b32 v128, v68, v64, s67
v_perm_b32 v132, v68, v64, s68
v_perm_b32 v136, v69, v65, s67
v_perm_b32 v140, v69, v65, s68
v_perm_b32 v144, v70, v66, s67
v_perm_b32 v148, v70, v66, s68
v_perm_b32 v152, v71, v67, s67
v_perm_b32 v156, v71, v67, s68
v_perm_b32 v129, v76, v72, s67
v_perm_b32 v133, v76, v72, s68
v_perm_b32 v137, v77, v73, s67
v_perm_b32 v141, v77, v73, s68
v_perm_b32 v145, v78, v74, s67
v_perm_b32 v149, v78, v74, s68
v_perm_b32 v153, v79, v75, s67
v_perm_b32 v157, v79, v75, s68
v_perm_b32 v130, v84, v80, s67
v_perm_b32 v134, v84, v80, s68
v_perm_b32 v138, v85, v81, s67
v_perm_b32 v142, v85, v81, s68
v_perm_b32 v146, v86, v82, s67
v_perm_b32 v150, v86, v82, s68
v_perm_b32 v154, v87, v83, s67
v_perm_b32 v158, v87, v83, s68
v_perm_b32 v131, v92, v88, s67
v_perm_b32 v135, v92, v88, s68
v_perm_b32 v139, v93, v89, s67
v_perm_b32 v143, v93, v89, s68
v_perm_b32 v147, v94, v90, s67
v_perm_b32 v151, v94, v90, s68
v_perm_b32 v155, v95, v91, s67
v_perm_b32 v159, v95, v91, s68
v_lshlrev_b32 v200, 16, v192
v_and_b32 v201, 0xffff0000, v192
v_lshlrev_b32 v202, 16, v193
v_and_b32 v203, 0xffff0000, v193
v_lshlrev_b32 v204, 16, v194
v_and_b32 v205, 0xffff0000, v194
v_lshlrev_b32 v206, 16, v195
v_and_b32 v207, 0xffff0000, v195
v_lshlrev_b32 v208, 16, v196
v_and_b32 v209, 0xffff0000, v196
v_lshlrev_b32 v210, 16, v197
v_and_b32 v211, 0xffff0000, v197
v_lshlrev_b32 v212, 16, v198
v_and_b32 v213, 0xffff0000, v198
v_lshlrev_b32 v214, 16, v199
v_and_b32 v215, 0xffff0000, v199
v_lshlrev_b32 v24, 16, v24
v_readfirstlane_b32 s52, v200
s_nop 1
v_subrev_f32 v200, s52, v200
v_subrev_f32 v201, s52, v201
v_subrev_f32 v202, s52, v202
v_subrev_f32 v203, s52, v203
v_subrev_f32 v204, s52, v204
v_subrev_f32 v205, s52, v205
v_subrev_f32 v206, s52, v206
v_subrev_f32 v207, s52, v207
v_subrev_f32 v208, s52, v208
v_subrev_f32 v209, s52, v209
v_subrev_f32 v210, s52, v210
v_subrev_f32 v211, s52, v211
v_subrev_f32 v212, s52, v212
v_subrev_f32 v213, s52, v213
v_subrev_f32 v214, s52, v214
v_subrev_f32 v215, s52, v215
v_add_f32 v216, v200, v201
v_add_f32 v218, v202, v203
v_mul_f32 v217, v200, v200
v_mul_f32 v219, v202, v202
v_fmac_f32 v217, v201, v201
v_fmac_f32 v219, v203, v203
v_add_f32 v216, v216, v204
v_add_f32 v218, v218, v205
v_fmac_f32 v217, v204, v204
v_fmac_f32 v219, v205, v205
v_add_f32 v216, v216, v206
v_add_f32 v218, v218, v207
v_fmac_f32 v217, v206, v206
v_fmac_f32 v219, v207, v207
v_add_f32 v216, v216, v208
v_add_f32 v218, v218, v209
v_fmac_f32 v217, v208, v208
v_fmac_f32 v219, v209, v209
v_add_f32 v216, v216, v210
v_add_f32 v218, v218, v211
v_fmac_f32 v217, v210, v210
v_fmac_f32 v219, v211, v211
v_add_f32 v216, v216, v212
v_add_f32 v218, v218, v213
v_fmac_f32 v217, v212, v212
v_fmac_f32 v219, v213, v213
v_add_f32 v216, v216, v214
v_add_f32 v218, v218, v215
v_fmac_f32 v217, v214, v214
v_fmac_f32 v219, v215, v215
v_add_f32 v216, v216, v218
v_add_f32 v217, v217, v219
s_nop 1
v_permlane16_swap_b32 v216, v217
s_nop 0
v_add_f32 v216, v216, v217
s_nop 1
v_add_f32_dpp v216, v216, v216 quad_perm:[1,0,3,2] row_mask:0xf bank_mask:0xf
s_nop 1
v_add_f32_dpp v216, v216, v216 quad_perm:[2,3,0,1] row_mask:0xf bank_mask:0xf
s_nop 1
v_add_f32_dpp v216, v216, v216 row_half_mirror row_mask:0xf bank_mask:0xf
s_nop 1
v_add_f32_dpp v216, v216, v216 row_mirror row_mask:0xf bank_mask:0xf
s_nop 0
v_readlane_b32 s53, v216, 0
v_readlane_b32 s54, v216, 16
v_readlane_b32 s55, v216, 32
v_readlane_b32 s56, v216, 48
s_nop 0
v_mov_b32 v216, s53
v_mov_b32 v217, s54
v_add_f32 v216, s55, v216
v_add_f32 v217, s56, v217
v_mul_f32 v216, 0x3a800000, v216
v_mul_f32 v217, 0x3a800000, v217
v_add_f32 v25, s52, v216
v_fma_f32 v217, -v216, v216, v217
v_max_f32 v217, 0, v217
v_cvt_pk_bf16_f32 v25, v25, v25
v_and_b32 v25, 0xffff0000, v25
v_cvt_pk_bf16_f32 v217, v217, v217
v_and_b32 v217, 0xffff0000, v217
v_add_f32 v217, 0x3727c5ac, v217
v_cvt_pk_bf16_f32 v217, v217, v217
v_and_b32 v217, 0xffff0000, v217
v_sqrt_f32 v217, v217
s_nop 0
v_cvt_pk_bf16_f32 v217, v217, v217
v_and_b32 v217, 0xffff0000, v217
v_rcp_f32 v26, v217
s_nop 0
v_sub_f32 v24, v24, v25
v_cvt_pk_bf16_f32 v24, v24, v24
v_and_b32 v24, 0xffff0000, v24
v_mul_f32 v24, v24, v26
v_cvt_pk_bf16_f32 v24, v24, v24
v_and_b32 v24, 0xffff0000, v24
s_lshl_b32 s50, s3, 7
s_add_u32 s50, s50, 0x200
v_lshl_add_u32 v20, v1, 1, s50
v_add_u32 v21, s50, v4
s_mov_b32 s51, 0x34000
s_lshl_b32 s53, s48, 3
s_add_u32 s53, s53, s3
s_lshl_b32 s53, s53, 11
s_add_u32 s53, s53, 0x20000
v_lshlrev_b32 v23, 4, v1
v_and_b32 v244, 31, v1
v_lshlrev_b32 v244, 3, v244
v_lshrrev_b32 v245, 5, v1
v_lshl_add_u32 v244, v245, 2, v244
s_lshl_b32 s50, s3, 8
v_add_u32 v244, s50, v244
s_waitcnt vmcnt(0)
v_perm_b32 v160, v100, v96, s67
v_perm_b32 v164, v100, v96, s68
v_perm_b32 v168, v101, v97, s67
v_perm_b32 v172, v101, v97, s68
v_perm_b32 v176, v102, v98, s67
v_perm_b32 v180, v102, v98, s68
v_perm_b32 v184, v103, v99, s67
v_perm_b32 v188, v103, v99, s68
v_perm_b32 v161, v108, v104, s67
v_perm_b32 v165, v108, v104, s68
v_perm_b32 v169, v109, v105, s67
v_perm_b32 v173, v109, v105, s68
v_perm_b32 v177, v110, v106, s67
v_perm_b32 v181, v110, v106, s68
v_perm_b32 v185, v111, v107, s67
v_perm_b32 v189, v111, v107, s68
v_perm_b32 v162, v116, v112, s67
v_perm_b32 v166, v116, v112, s68
v_perm_b32 v170, v117, v113, s67
v_perm_b32 v174, v117, v113, s68
v_perm_b32 v178, v118, v114, s67
v_perm_b32 v182, v118, v114, s68
v_perm_b32 v186, v119, v115, s67
v_perm_b32 v190, v119, v115, s68
v_perm_b32 v163, v124, v120, s67
v_perm_b32 v167, v124, v120, s68
v_perm_b32 v171, v125, v121, s67
v_perm_b32 v175, v125, v121, s68
v_perm_b32 v179, v126, v122, s67
v_perm_b32 v183, v126, v122, s68
v_perm_b32 v187, v127, v123, s67
v_perm_b32 v191, v127, v123, s68
s_barrier
s_mov_b32 s64, 0
buffer_load_dwordx2 v[26:27], v22, s[40:43], s51 offen offset:0 sc1
v_and_b32 v224, 31, v1
v_lshlrev_b32 v224, 3, v224
s_and_b32 s50, s2, 7
s_lshl_b32 s50, s50, 8
s_add_u32 s50, s50, 0x3a000
buffer_load_dwordx2 v[226:227], v224, s[40:43], s50 offen offset:0 sc1
s_waitcnt vmcnt(1)
s_branch pchk_44
poll_42:
buffer_load_dwordx2 v[26:27], v22, s[40:43], s51 offen offset:0 sc1
s_waitcnt vmcnt(0)
pchk_44:
v_cmp_ne_u32 vcc, s31, v27
s_cbranch_vccz pdone_43
s_add_u32 s64, s64, 1
s_cmp_lt_u32 s64, 1000000
s_cbranch_scc1 poll_42
pdone_43:
v_and_b32 v27, 0xffff0000, v26
v_lshlrev_b32 v26, 16, v26
v_mul_f32 v24, v24, v27
v_cvt_pk_bf16_f32 v24, v24, v24
v_and_b32 v24, 0xffff0000, v24
v_add_f32 v24, v24, v26
v_cvt_pk_bf16_f32 v24, v24, v24
ds_write_b16 v20, v24
ds_read_b128 v[16:19], v21
ds_read_b128 v[24:27], v21 offset:64
s_waitcnt lgkmcnt(1)
v_mfma_f32_16x16x32_bf16 v[32:35], v[16:19], v[128:131], 0
v_mfma_f32_16x16x32_bf16 v[36:39], v[16:19], v[132:135], 0
v_mfma_f32_16x16x32_bf16 v[40:43], v[16:19], v[136:139], 0
v_mfma_f32_16x16x32_bf16 v[44:47], v[16:19], v[140:143], 0
v_mfma_f32_16x16x32_bf16 v[48:51], v[16:19], v[144:147], 0
v_mfma_f32_16x16x32_bf16 v[52:55], v[16:19], v[148:151], 0
v_mfma_f32_16x16x32_bf16 v[56:59], v[16:19], v[152:155], 0
v_mfma_f32_16x16x32_bf16 v[60:63], v[16:19], v[156:159], 0
s_waitcnt lgkmcnt(0)
v_mfma_f32_16x16x32_bf16 v[32:35], v[24:27], v[160:163], v[32:35]
v_mfma_f32_16x16x32_bf16 v[36:39], v[24:27], v[164:167], v[36:39]
v_mfma_f32_16x16x32_bf16 v[40:43], v[24:27], v[168:171], v[40:43]
v_mfma_f32_16x16x32_bf16 v[44:47], v[24:27], v[172:175], v[44:47]
v_mfma_f32_16x16x32_bf16 v[48:51], v[24:27], v[176:179], v[48:51]
v_mfma_f32_16x16x32_bf16 v[52:55], v[24:27], v[180:183], v[52:55]
v_mfma_f32_16x16x32_bf16 v[56:59], v[24:27], v[184:187], v[56:59]
v_mfma_f32_16x16x32_bf16 v[60:63], v[24:27], v[188:191], v[60:63]
s_waitcnt vmcnt(0)
v_xor_b32 v226, s66, v226
v_xor_b32 v227, s31, v227
v_or_b32 v226, v226, v227
v_cmp_ne_u32 vcc, 0, v226
s_cmp_eq_u64 vcc, 0
s_cselect_b32 s65, 1, 0
s_nop 0
v_mov_b32_dpp v28, v32 quad_perm:[0,1,2,3] row_mask:0x1 bank_mask:0xf
v_mov_b32_dpp v29, v36 quad_perm:[0,1,2,3] row_mask:0x1 bank_mask:0xf
v_mov_b32_dpp v28, v40 quad_perm:[0,1,2,3] row_mask:0x2 bank_mask:0xf
v_mov_b32_dpp v29, v44 quad_perm:[0,1,2,3] row_mask:0x2 bank_mask:0xf
v_mov_b32_dpp v28, v48 quad_perm:[0,1,2,3] row_mask:0x4 bank_mask:0xf
v_mov_b32_dpp v29, v52 quad_perm:[0,1,2,3] row_mask:0x4 bank_mask:0xf
v_mov_b32_dpp v28, v56 quad_perm:[0,1,2,3] row_mask:0x8 bank_mask:0xf
v_mov_b32_dpp v29, v60 quad_perm:[0,1,2,3] row_mask:0x8 bank_mask:0xf
ds_write_b64 v8, v[28:29]
s_waitcnt lgkmcnt(0)
s_barrier
s_cmp_lg_u32 s3, 0
s_cbranch_scc1 sk_45
ds_read_b64 v[48:49], v10 offset:1024
ds_read_b64 v[50:51], v10 offset:1536
ds_read_b64 v[52:53], v10 offset:2048
ds_read_b64 v[54:55], v10 offset:2560
s_waitcnt lgkmcnt(0)
v_add_f32 v48, v48, v50
v_add_f32 v49, v49, v51
v_add_f32 v52, v52, v54
v_add_f32 v53, v53, v55
v_add_f32 v48, v48, v52
v_add_f32 v49, v49, v53
v_add_u32 v48, 8, v48
v_and_or_b32 v48, v48, s69, v252
v_add_u32 v49, 8, v49
v_and_or_b32 v49, v49, s69, v253
buffer_store_dwordx2 v[48:49], v10, s[40:43], s61 offen
s_cmp_eq_u32 s65, 1
s_cbranch_scc1 sk_46
buffer_store_dwordx2 v[48:49], v10, s[40:43], s61 offen sc1
sk_46:
sk_45:
s_mov_b32 s64, 0
poll_47:
buffer_load_dwordx4 v[32:35], v23, s[40:43], s53 offen offset:0 sc1
buffer_load_dwordx4 v[36:39], v23, s[40:43], s53 offen offset:1024 sc1
s_waitcnt vmcnt(0)
pchk_49:
v_xor_b32 v32, v248, v32
v_xor_b32 v33, v249, v33
v_xor_b32 v34, v250, v34
v_xor_b32 v35, v251, v35
v_xor_b32 v36, v248, v36
v_xor_b32 v37, v249, v37
v_xor_b32 v38, v250, v38
v_xor_b32 v39, v251, v39
v_or3_b32 v28, v32, v33, v34
v_or3_b32 v28, v28, v35, v36
v_or3_b32 v28, v28, v37, v38
v_or_b32 v28, v28, v39
v_and_b32 v28, 15, v28
v_cmp_ne_u32 vcc, 0, v28
s_cbranch_vccz pdone_48
s_add_u32 s64, s64, 1
s_cmp_lt_u32 s64, 1000000
s_cbranch_scc1 poll_47
pdone_48:
v_add_f32 v32, v32, v36
v_add_f32 v33, v33, v37
v_add_f32 v34, v34, v38
v_add_f32 v35, v35, v39
s_nop 0
v_permlane32_swap_b32 v32, v34
v_permlane32_swap_b32 v33, v35
v_add_f32 v32, v32, v34
v_add_f32 v33, v33, v35
v_cvt_pk_bf16_f32 v32, v32, v33
ds_write_b32 v244, v32 offset:5120
s_waitcnt lgkmcnt(0)
s_barrier
s_cmp_ge_u32 s3, 2
s_cbranch_scc1 sk_50
buffer_load_dwordx4 v[96:99], v13, s[36:39], s58 offen nt
s_add_u32 s50, s58, 0x3000
buffer_load_dwordx4 v[100:103], v13, s[36:39], s50 offen nt
s_add_u32 s50, s58, 0x6000
buffer_load_dwordx4 v[104:107], v13, s[36:39], s50 offen nt
s_add_u32 s50, s58, 0x9000
buffer_load_dwordx4 v[108:111], v13, s[36:39], s50 offen nt
s_add_u32 s50, s58, 0xc000
buffer_load_dwordx4 v[112:115], v13, s[36:39], s50 offen nt
s_add_u32 s50, s58, 0xf000
buffer_load_dwordx4 v[116:119], v13, s[36:39], s50 offen nt
s_add_u32 s50, s58, 0x12000
buffer_load_dwordx4 v[120:123], v13, s[36:39], s50 offen nt
s_add_u32 s50, s58, 0x15000
buffer_load_dwordx4 v[124:127], v13, s[36:39], s50 offen nt
sk_50:
s_mov_b32 s50, 57344
v_mul_lo_u32 v12, v3, s50
v_add_u32 v12, v12, v2
s_and_b32 s59, s49, 7
s_xor_b32 s59, s59, s3
s_lshl_b32 s50, s48, 3
s_add_u32 s59, s59, s50
s_mul_i32 s54, s59, 229376
s_xor_b32 s50, s49, 0
s_lshl_b32 s50, s50, 8
s_add_u32 s54, s54, s50
s_mov_b32 s32, s16
s_mov_b32 s33, s17
s_mov_b32 s34, 0x700000
s_mov_b32 s35, 0x20000
s_barrier
s_barrier
s_cmp_lt_u32 s3, 2
s_cbranch_scc1 sk_51
buffer_load_dwordx4 v[96:99], v13, s[36:39], s58 offen nt
s_add_u32 s50, s58, 0x3000
buffer_load_dwordx4 v[100:103], v13, s[36:39], s50 offen nt
s_add_u32 s50, s58, 0x6000
buffer_load_dwordx4 v[104:107], v13, s[36:39], s50 offen nt
s_add_u32 s50, s58, 0x9000
buffer_load_dwordx4 v[108:111], v13, s[36:39], s50 offen nt
s_add_u32 s50, s58, 0xc000
buffer_load_dwordx4 v[112:115], v13, s[36:39], s50 offen nt
s_add_u32 s50, s58, 0xf000
buffer_load_dwordx4 v[116:119], v13, s[36:39], s50 offen nt
s_add_u32 s50, s58, 0x12000
buffer_load_dwordx4 v[120:123], v13, s[36:39], s50 offen nt
s_add_u32 s50, s58, 0x15000
buffer_load_dwordx4 v[124:127], v13, s[36:39], s50 offen nt
sk_51:
s_barrier
s_waitcnt vmcnt(6)
v_perm_b32 v128, v100, v96, s67
v_perm_b32 v132, v100, v96, s68
v_perm_b32 v136, v101, v97, s67
v_perm_b32 v140, v101, v97, s68
v_perm_b32 v144, v102, v98, s67
v_perm_b32 v148, v102, v98, s68
v_perm_b32 v152, v103, v99, s67
v_perm_b32 v156, v103, v99, s68
s_waitcnt vmcnt(4)
v_perm_b32 v129, v108, v104, s67
v_perm_b32 v133, v108, v104, s68
v_perm_b32 v137, v109, v105, s67
v_perm_b32 v141, v109, v105, s68
v_perm_b32 v145, v110, v106, s67
v_perm_b32 v149, v110, v106, s68
v_perm_b32 v153, v111, v107, s67
v_perm_b32 v157, v111, v107, s68
s_waitcnt vmcnt(2)
v_perm_b32 v130, v116, v112, s67
v_perm_b32 v134, v116, v112, s68
v_perm_b32 v138, v117, v113, s67
v_perm_b32 v142, v117, v113, s68
v_perm_b32 v146, v118, v114, s67
v_perm_b32 v150, v118, v114, s68
v_perm_b32 v154, v119, v115, s67
v_perm_b32 v158, v119, v115, s68
s_waitcnt vmcnt(0)
v_perm_b32 v131, v124, v120, s67
v_perm_b32 v135, v124, v120, s68
v_perm_b32 v139, v125, v121, s67
v_perm_b32 v143, v125, v121, s68
v_perm_b32 v147, v126, v122, s67
v_perm_b32 v151, v126, v122, s68
v_perm_b32 v155, v127, v123, s67
v_perm_b32 v159, v127, v123, s68
v_mfma_f32_16x16x32_bf16 v[32:35], v[240:243], v[128:131], 0
v_mfma_f32_16x16x32_bf16 v[36:39], v[240:243], v[132:135], 0
v_mfma_f32_16x16x32_bf16 v[40:43], v[240:243], v[136:139], 0
v_mfma_f32_16x16x32_bf16 v[44:47], v[240:243], v[140:143], 0
v_mfma_f32_16x16x32_bf16 v[48:51], v[240:243], v[144:147], 0
v_mfma_f32_16x16x32_bf16 v[52:55], v[240:243], v[148:151], 0
v_mfma_f32_16x16x32_bf16 v[56:59], v[240:243], v[152:155], 0
v_mfma_f32_16x16x32_bf16 v[60:63], v[240:243], v[156:159], 0
s_nop 0
v_mov_b32_dpp v28, v32 quad_perm:[0,1,2,3] row_mask:0x1 bank_mask:0xf
v_mov_b32_dpp v29, v36 quad_perm:[0,1,2,3] row_mask:0x1 bank_mask:0xf
v_mov_b32_dpp v28, v40 quad_perm:[0,1,2,3] row_mask:0x2 bank_mask:0xf
v_mov_b32_dpp v29, v44 quad_perm:[0,1,2,3] row_mask:0x2 bank_mask:0xf
v_mov_b32_dpp v28, v48 quad_perm:[0,1,2,3] row_mask:0x4 bank_mask:0xf
v_mov_b32_dpp v29, v52 quad_perm:[0,1,2,3] row_mask:0x4 bank_mask:0xf
v_mov_b32_dpp v28, v56 quad_perm:[0,1,2,3] row_mask:0x8 bank_mask:0xf
v_mov_b32_dpp v29, v60 quad_perm:[0,1,2,3] row_mask:0x8 bank_mask:0xf
ds_write_b64 v8, v[28:29]
s_waitcnt lgkmcnt(0)
s_barrier
s_cmp_lg_u32 s3, 0
s_cbranch_scc1 sk_52
ds_read_b64 v[48:49], v10 offset:1024
ds_read_b64 v[50:51], v10 offset:1536
ds_read_b64 v[52:53], v10 offset:2048
ds_read_b64 v[54:55], v10 offset:2560
s_waitcnt lgkmcnt(0)
v_add_f32 v48, v48, v50
v_add_f32 v49, v49, v51
v_add_f32 v52, v52, v54
v_add_f32 v53, v53, v55
v_add_f32 v48, v48, v52
v_add_f32 v49, v49, v53
v_add_u32 v48, 8, v48
v_and_or_b32 v48, v48, s69, v252
v_add_u32 v49, 8, v49
v_and_or_b32 v49, v49, s69, v253
buffer_store_dwordx2 v[48:49], v10, s[40:43], s62 offen
s_cmp_eq_u32 s65, 1
s_cbranch_scc1 sk_53
buffer_store_dwordx2 v[48:49], v10, s[40:43], s62 offen sc1
sk_53:
sk_52:
s_cmp_ge_u32 s49, 28
s_cbranch_scc1 L_p_cs
s_barrier
buffer_load_dwordx4 v[64:67], v12, s[32:35], s54 offen nt
s_add_u32 s50, s54, 0x1c00
buffer_load_dwordx4 v[68:71], v12, s[32:35], s50 offen nt
s_add_u32 s50, s54, 0x3800
buffer_load_dwordx4 v[72:75], v12, s[32:35], s50 offen nt
s_add_u32 s50, s54, 0x5400
buffer_load_dwordx4 v[76:79], v12, s[32:35], s50 offen nt
s_add_u32 s50, s54, 0x7000
buffer_load_dwordx4 v[80:83], v12, s[32:35], s50 offen nt
s_add_u32 s50, s54, 0x8c00
buffer_load_dwordx4 v[84:87], v12, s[32:35], s50 offen nt
s_add_u32 s50, s54, 0xa800
buffer_load_dwordx4 v[88:91], v12, s[32:35], s50 offen nt
s_add_u32 s50, s54, 0xc400
buffer_load_dwordx4 v[92:95], v12, s[32:35], s50 offen nt
s_mov_b32 s58, 0
s_branch L_p_w1
L_p_a:
s_setprio 3
s_getreg_b32 s66, hwreg(HW_REG_XCC_ID, 0, 4)
s_mov_b32 s67, 0x05040100
s_mov_b32 s68, 0x07060302
s_mov_b32 s69, 0xfffffff0
s_mov_b32 s65, 0
v_lshlrev_b32 v4, 4, v3
v_lshlrev_b32 v5, 1, v2
v_lshl_add_u32 v5, v3, 3, v5
s_lshl_b32 s50, s3, 9
s_add_u32 s50, s50, 0x400
v_add_u32 v8, s50, v5
v_lshlrev_b32 v9, 2, v1
s_and_b32 s50, s3, 1
s_lshl_b32 s50, s50, 8
v_add_u32 v6, s50, v9
s_lshl_b32 s50, s3, 6
s_add_u32 s50, s50, 0x200
v_add_u32 v7, s50, v4
v_lshlrev_b32 v10, 3, v1
s_sub_u32 s59, s3, 4
v_lshlrev_b32 v14, 4, v1
v_bfe_u32 v13, v1, 1, 3
v_lshlrev_b32 v13, 8, v13
v_and_b32 v12, 1, v1
v_lshl_add_u32 v13, v12, 6, v13
v_add_u32 v13, v13, v4
s_lshl_b32 s57, s48, 24
s_add_u32 s57, s57, 0xF00000
s_lshl_b32 s50, s49, 15
s_add_u32 s57, s57, s50
s_lshl_b32 s50, s59, 13
s_add_u32 s57, s57, s50
s_add_u32 s58, s57, 4096
s_waitcnt lgkmcnt(0)
s_load_dword s30, s[28:29], 0
s_mov_b32 s40, s28
s_mov_b32 s41, s29
s_mov_b32 s42, 0x10000000
s_mov_b32 s43, 0x20000
s_mov_b32 s36, s6
s_mov_b32 s37, s7
s_mov_b32 s38, 0x4000000
s_mov_b32 s39, 0x20000
s_lshl_b32 s55, s48, 5
s_add_u32 s55, s55, s49
s_lshl_b32 s60, s55, 2
s_add_u32 s60, s60, s59
s_lshl_b32 s60, s60, 10
s_add_u32 s60, s60, 0x180000
s_lshl_b32 s54, s49, 2
s_add_u32 s54, s54, s48
s_lshl_b32 s54, s54, 9
s_add_u32 s54, s54, 0x60000
s_lshl_b32 s53, s55, 9
s_add_u32 s53, s53, 0x20000
s_cmp_eq_u32 s59, 0
s_cselect_b32 s54, s53, s54
s_lshl_b32 s52, s48, 7
s_add_u32 s52, s52, 0x37800
s_waitcnt lgkmcnt(0)
s_add_u32 s31, s30, 0x9e3779b9
s_mul_i32 s31, s31, 0x85ebca6b
s_lshr_b32 s50, s31, 15
s_xor_b32 s31, s31, s50
s_mul_i32 s31, s31, 0xc2b2ae35
s_lshr_b32 s50, s31, 13
s_xor_b32 s31, s31, s50
s_or_b32 s31, s31, 0x11111111
s_xor_b32 s31, s31, s30
v_and_b32 v11, 7, v1
v_lshlrev_b32 v11, 2, v11
v_bfe_u32 v11, s31, v11, 4
v_and_b32 v251, 1, v1
v_lshlrev_b32 v251, 4, v251
v_lshrrev_b32 v251, v251, s31
v_bfe_u32 v248, v251, 0, 4
v_bfe_u32 v249, v251, 4, 4
v_bfe_u32 v250, v251, 8, 4
v_bfe_u32 v251, v251, 12, 4
v_and_b32 v253, 3, v1
v_lshlrev_b32 v253, 3, v253
v_lshrrev_b32 v253, v253, s31
v_bfe_u32 v252, v253, 0, 4
v_bfe_u32 v253, v253, 4, 4
s_cmp_lg_u32 s3, 4
s_cbranch_scc1 sk_54
s_and_b32 s50, s2, 7
s_lshl_b32 s50, s50, 5
s_add_u32 s50, s50, s49
s_lshl_b32 s50, s50, 3
s_add_u32 s50, s50, 0x3a000
v_mov_b32 v28, s66
v_mov_b32 v29, s31
s_mov_b64 exec, 1
buffer_store_dwordx2 v[28:29], v10, s[40:43], s50 offen
s_mov_b64 exec, -1
sk_54:
s_setprio 0
v_mov_b32 v31, s31
s_lshl_b32 s61, s49, 3
s_add_u32 s61, s61, s3
s_barrier
buffer_load_dwordx4 v[160:163], v13, s[36:39], s57 offen offset:0 nt
buffer_load_dwordx4 v[164:167], v13, s[36:39], s57 offen offset:128 nt
buffer_load_dwordx4 v[168:171], v13, s[36:39], s57 offen offset:2048 nt
buffer_load_dwordx4 v[172:175], v13, s[36:39], s57 offen offset:2176 nt
buffer_load_dwordx4 v[176:179], v13, s[36:39], s58 offen offset:0 nt
buffer_load_dwordx4 v[180:183], v13, s[36:39], s58 offen offset:128 nt
buffer_load_dwordx4 v[184:187], v13, s[36:39], s58 offen offset:2048 nt
buffer_load_dwordx4 v[188:191], v13, s[36:39], s58 offen offset:2176 nt
s_barrier
v_and_b32 v12, 7, v1
v_bfe_u32 v13, v1, 3, 1
v_lshlrev_b32 v15, 8, v12
v_lshl_add_u32 v15, v13, 6, v15
v_add_u32 v15, v15, v4
v_lshlrev_b32 v26, 5, v12
s_lshl_b32 s50, s59, 3
v_add_u32 v25, s50, v26
s_cmp_ge_u32 s59, 2
s_cbranch_scc1 sk_55
buffer_load_dword v236, v10, s[40:43], s54 offen offset:0 sc1
sk_55:
s_mov_b32 s50, 57344
v_mul_lo_u32 v12, v3, s50
v_add_u32 v12, v12, v2
s_and_b32 s59, s49, 7
s_xor_b32 s59, s59, s3
s_lshl_b32 s50, s48, 3
s_add_u32 s59, s59, s50
s_mul_i32 s54, s59, 229376
s_xor_b32 s50, s49, 0
s_lshl_b32 s50, s50, 8
s_add_u32 s54, s54, s50
s_mov_b32 s32, s16
s_mov_b32 s33, s17
s_mov_b32 s34, 0x700000
s_mov_b32 s35, 0x20000
s_mov_b32 s57, s54
s_mov_b32 s36, s22
s_mov_b32 s37, s23
s_mov_b32 s38, 0xc00000
s_mov_b32 s39, 0x20000
s_mov_b32 s50, 98304
v_mul_lo_u32 v13, v3, s50
v_add_u32 v13, v13, v2
s_mov_b32 s50, 0xddddddd
s_bitcmp1_b32 s50, s49
s_cselect_b32 s58, s3, 0
s_cmp_lg_u32 s3, 4
s_cbranch_scc1 sk_56
s_lshr_b32 s50, s49, 1
s_lshl_b32 s50, s50, 7
s_load_dwordx16 s[4:19], s[20:21], s50
s_waitcnt lgkmcnt(0)
s_mov_b32 exec_lo, 0xffff
s_mov_b32 exec_hi, 0x0
v_mov_b32 v224, s4
v_mov_b32 v225, s5
v_mov_b32 v226, s6
v_mov_b32 v227, s7
s_mov_b32 exec_lo, 0xffff0000
s_mov_b32 exec_hi, 0x0
v_mov_b32 v224, s8
v_mov_b32 v225, s9
v_mov_b32 v226, s10
v_mov_b32 v227, s11
s_mov_b32 exec_lo, 0x0
s_mov_b32 exec_hi, 0xffff
v_mov_b32 v224, s12
v_mov_b32 v225, s13
v_mov_b32 v226, s14
v_mov_b32 v227, s15
s_mov_b32 exec_lo, 0x0
s_mov_b32 exec_hi, 0xffff0000
v_mov_b32 v224, s16
v_mov_b32 v225, s17
v_mov_b32 v226, s18
v_mov_b32 v227, s19
s_mov_b64 exec, -1
s_add_u32 s50, s50, 64
s_load_dwordx16 s[4:19], s[20:21], s50
s_waitcnt lgkmcnt(0)
s_mov_b32 exec_lo, 0xffff
s_mov_b32 exec_hi, 0x0
v_mov_b32 v228, s4
v_mov_b32 v229, s5
v_mov_b32 v230, s6
v_mov_b32 v231, s7
s_mov_b32 exec_lo, 0xffff0000
s_mov_b32 exec_hi, 0x0
v_mov_b32 v228, s8
v_mov_b32 v229, s9
v_mov_b32 v230, s10
v_mov_b32 v231, s11
s_mov_b32 exec_lo, 0x0
s_mov_b32 exec_hi, 0xffff
v_mov_b32 v228, s12
v_mov_b32 v229, s13
v_mov_b32 v230, s14
v_mov_b32 v231, s15
s_mov_b32 exec_lo, 0x0
s_mov_b32 exec_hi, 0xffff0000
v_mov_b32 v228, s16
v_mov_b32 v229, s17
v_mov_b32 v230, s18
v_mov_b32 v231, s19
s_mov_b64 exec, -1
s_load_dwordx16 s[4:19], s[0:1], 0
v_lshlrev_b32 v32, 16, v224
v_and_b32 v33, 0xffff0000, v224
v_lshlrev_b32 v34, 16, v225
v_and_b32 v35, 0xffff0000, v225
v_mul_f32 v36, 0xbfb8aa3b, v32
v_mul_f32 v37, 0xbfb8aa3b, v33
v_mul_f32 v38, 0xbfb8aa3b, v34
v_mul_f32 v39, 0xbfb8aa3b, v35
v_exp_f32 v36, v36
v_exp_f32 v37, v37
v_exp_f32 v38, v38
v_exp_f32 v39, v39
v_add_f32 v36, 1.0, v36
v_add_f32 v37, 1.0, v37
v_add_f32 v38, 1.0, v38
v_add_f32 v39, 1.0, v39
v_min_f32 v36, 0x7f000000, v36
v_min_f32 v37, 0x7f000000, v37
v_min_f32 v38, 0x7f000000, v38
v_min_f32 v39, 0x7f000000, v39
v_rcp_f32 v40, v36
v_rcp_f32 v41, v37
v_rcp_f32 v42, v38
v_rcp_f32 v43, v39
v_mul_f32 v44, v32, v40
v_mul_f32 v45, v33, v41
v_mul_f32 v46, v34, v42
v_mul_f32 v47, v35, v43
v_fma_f32 v32, -v44, v36, v32
v_fma_f32 v33, -v45, v37, v33
v_fma_f32 v34, -v46, v38, v34
v_fma_f32 v35, -v47, v39, v35
v_fma_f32 v32, v32, v40, v44
v_fma_f32 v33, v33, v41, v45
v_fma_f32 v34, v34, v42, v46
v_fma_f32 v35, v35, v43, v47
v_cvt_pk_bf16_f32 v224, v32, v33
v_cvt_pk_bf16_f32 v225, v34, v35
v_lshlrev_b32 v32, 16, v226
v_and_b32 v33, 0xffff0000, v226
v_lshlrev_b32 v34, 16, v227
v_and_b32 v35, 0xffff0000, v227
v_mul_f32 v36, 0xbfb8aa3b, v32
v_mul_f32 v37, 0xbfb8aa3b, v33
v_mul_f32 v38, 0xbfb8aa3b, v34
v_mul_f32 v39, 0xbfb8aa3b, v35
v_exp_f32 v36, v36
v_exp_f32 v37, v37
v_exp_f32 v38, v38
v_exp_f32 v39, v39
v_add_f32 v36, 1.0, v36
v_add_f32 v37, 1.0, v37
v_add_f32 v38, 1.0, v38
v_add_f32 v39, 1.0, v39
v_min_f32 v36, 0x7f000000, v36
v_min_f32 v37, 0x7f000000, v37
v_min_f32 v38, 0x7f000000, v38
v_min_f32 v39, 0x7f000000, v39
v_rcp_f32 v40, v36
v_rcp_f32 v41, v37
v_rcp_f32 v42, v38
v_rcp_f32 v43, v39
v_mul_f32 v44, v32, v40
v_mul_f32 v45, v33, v41
v_mul_f32 v46, v34, v42
v_mul_f32 v47, v35, v43
v_fma_f32 v32, -v44, v36, v32
v_fma_f32 v33, -v45, v37, v33
v_fma_f32 v34, -v46, v38, v34
v_fma_f32 v35, -v47, v39, v35
v_fma_f32 v32, v32, v40, v44
v_fma_f32 v33, v33, v41, v45
v_fma_f32 v34, v34, v42, v46
v_fma_f32 v35, v35, v43, v47
v_cvt_pk_bf16_f32 v226, v32, v33
v_cvt_pk_bf16_f32 v227, v34, v35
v_lshlrev_b32 v32, 16, v228
v_and_b32 v33, 0xffff0000, v228
v_lshlrev_b32 v34, 16, v229
v_and_b32 v35, 0xffff0000, v229
v_mul_f32 v36, 0xbfb8aa3b, v32
v_mul_f32 v37, 0xbfb8aa3b, v33
v_mul_f32 v38, 0xbfb8aa3b, v34
v_mul_f32 v39, 0xbfb8aa3b, v35
v_exp_f32 v36, v36
v_exp_f32 v37, v37
v_exp_f32 v38, v38
v_exp_f32 v39, v39
v_add_f32 v36, 1.0, v36
v_add_f32 v37, 1.0, v37
v_add_f32 v38, 1.0, v38
v_add_f32 v39, 1.0, v39
v_min_f32 v36, 0x7f000000, v36
v_min_f32 v37, 0x7f000000, v37
v_min_f32 v38, 0x7f000000, v38
v_min_f32 v39, 0x7f000000, v39
v_rcp_f32 v40, v36
v_rcp_f32 v41, v37
v_rcp_f32 v42, v38
v_rcp_f32 v43, v39
v_mul_f32 v44, v32, v40
v_mul_f32 v45, v33, v41
v_mul_f32 v46, v34, v42
v_mul_f32 v47, v35, v43
v_fma_f32 v32, -v44, v36, v32
v_fma_f32 v33, -v45, v37, v33
v_fma_f32 v34, -v46, v38, v34
v_fma_f32 v35, -v47, v39, v35
v_fma_f32 v32, v32, v40, v44
v_fma_f32 v33, v33, v41, v45
v_fma_f32 v34, v34, v42, v46
v_fma_f32 v35, v35, v43, v47
v_cvt_pk_bf16_f32 v228, v32, v33
v_cvt_pk_bf16_f32 v229, v34, v35
v_lshlrev_b32 v32, 16, v230
v_and_b32 v33, 0xffff0000, v230
v_lshlrev_b32 v34, 16, v231
v_and_b32 v35, 0xffff0000, v231
v_mul_f32 v36, 0xbfb8aa3b, v32
v_mul_f32 v37, 0xbfb8aa3b, v33
v_mul_f32 v38, 0xbfb8aa3b, v34
v_mul_f32 v39, 0xbfb8aa3b, v35
v_exp_f32 v36, v36
v_exp_f32 v37, v37
v_exp_f32 v38, v38
v_exp_f32 v39, v39
v_add_f32 v36, 1.0, v36
v_add_f32 v37, 1.0, v37
v_add_f32 v38, 1.0, v38
v_add_f32 v39, 1.0, v39
v_min_f32 v36, 0x7f000000, v36
v_min_f32 v37, 0x7f000000, v37
v_min_f32 v38, 0x7f000000, v38
v_min_f32 v39, 0x7f000000, v39
v_rcp_f32 v40, v36
v_rcp_f32 v41, v37
v_rcp_f32 v42, v38
v_rcp_f32 v43, v39
v_mul_f32 v44, v32, v40
v_mul_f32 v45, v33, v41
v_mul_f32 v46, v34, v42
v_mul_f32 v47, v35, v43
v_fma_f32 v32, -v44, v36, v32
v_fma_f32 v33, -v45, v37, v33
v_fma_f32 v34, -v46, v38, v34
v_fma_f32 v35, -v47, v39, v35
v_fma_f32 v32, v32, v40, v44
v_fma_f32 v33, v33, v41, v45
v_fma_f32 v34, v34, v42, v46
v_fma_f32 v35, v35, v43, v47
v_cvt_pk_bf16_f32 v230, v32, v33
v_cvt_pk_bf16_f32 v231, v34, v35
s_waitcnt lgkmcnt(0)
s_lshr_b32 s53, s49, 1
s_lshl_b32 s55, s48, 1
s_and_b32 s50, s49, 1
s_add_u32 s55, s55, s50
s_xor_b32 s55, s55, 1
s_mul_i32 s54, s53, 786432
s_lshl_b32 s50, s55, 8
s_add_u32 s54, s54, s50
s_add_u32 s54, s54, 10240
s_lshl_b32 s56, s55, 4
s_add_u32 s56, s56, s53
s_lshl_b32 s56, s56, 9
s_add_u32 s56, s56, 0xb0000
sk_56:
s_lshl_b32 s53, s48, 3
s_add_u32 s53, s53, s3
s_lshl_b32 s53, s53, 11
s_add_u32 s53, s53, 0x20000
v_lshlrev_b32 v23, 4, v1
v_and_b32 v244, 31, v1
v_lshlrev_b32 v244, 3, v244
v_lshrrev_b32 v245, 5, v1
v_lshl_add_u32 v244, v245, 2, v244
s_lshl_b32 s50, s3, 8
v_add_u32 v244, s50, v244
s_barrier
s_mov_b32 s64, 0
poll_57:
buffer_load_dwordx4 v[32:35], v23, s[40:43], s53 offen offset:0 sc1
buffer_load_dwordx4 v[36:39], v23, s[40:43], s53 offen offset:1024 sc1
s_waitcnt vmcnt(0)
pchk_59:
v_xor_b32 v32, v248, v32
v_xor_b32 v33, v249, v33
v_xor_b32 v34, v250, v34
v_xor_b32 v35, v251, v35
v_xor_b32 v36, v248, v36
v_xor_b32 v37, v249, v37
v_xor_b32 v38, v250, v38
v_xor_b32 v39, v251, v39
v_or3_b32 v28, v32, v33, v34
v_or3_b32 v28, v28, v35, v36
v_or3_b32 v28, v28, v37, v38
v_or_b32 v28, v28, v39
v_and_b32 v28, 15, v28
v_cmp_ne_u32 vcc, 0, v28
s_cbranch_vccz pdone_58
s_add_u32 s64, s64, 1
s_cmp_lt_u32 s64, 1000000
s_cbranch_scc1 poll_57
pdone_58:
v_add_f32 v32, v32, v36
v_add_f32 v33, v33, v37
v_add_f32 v34, v34, v38
v_add_f32 v35, v35, v39
s_nop 0
v_permlane32_swap_b32 v32, v34
v_permlane32_swap_b32 v33, v35
v_add_f32 v32, v32, v34
v_add_f32 v33, v33, v35
v_cvt_pk_bf16_f32 v32, v32, v33
ds_write_b32 v244, v32 offset:5120
s_waitcnt lgkmcnt(0)
s_barrier
ds_read_b128 v[16:19], v15 offset:5120
ds_read_b128 v[20:23], v15 offset:5248
s_mov_b32 s50, 0x3fb8aa3b
s_waitcnt lgkmcnt(1)
v_mfma_f32_16x16x32_bf16 v[32:35], v[160:163], v[16:19], 0
v_mfma_f32_16x16x32_bf16 v[36:39], v[168:171], v[16:19], 0
v_mfma_f32_16x16x32_bf16 v[40:43], v[176:179], v[16:19], 0
v_mfma_f32_16x16x32_bf16 v[44:47], v[184:187], v[16:19], 0
s_waitcnt lgkmcnt(0)
v_mfma_f32_16x16x32_bf16 v[32:35], v[164:167], v[20:23], v[32:35]
v_mfma_f32_16x16x32_bf16 v[36:39], v[172:175], v[20:23], v[36:39]
v_mfma_f32_16x16x32_bf16 v[40:43], v[180:183], v[20:23], v[40:43]
v_mfma_f32_16x16x32_bf16 v[44:47], v[188:191], v[20:23], v[44:47]
s_nop 4
v_add_f32_dpp v48, v33, v32 row_ror:8 row_mask:0xf bank_mask:0x3
v_add_f32_dpp v48, v34, v35 row_ror:8 row_mask:0xf bank_mask:0xc
v_add_f32_dpp v49, v37, v36 row_ror:8 row_mask:0xf bank_mask:0x3
v_add_f32_dpp v49, v38, v39 row_ror:8 row_mask:0xf bank_mask:0xc
v_add_f32_dpp v50, v41, v40 row_ror:8 row_mask:0xf bank_mask:0x3
v_add_f32_dpp v50, v42, v43 row_ror:8 row_mask:0xf bank_mask:0xc
v_add_f32_dpp v51, v45, v44 row_ror:8 row_mask:0xf bank_mask:0x3
v_add_f32_dpp v51, v46, v47 row_ror:8 row_mask:0xf bank_mask:0xc
v_max3_f32 v54, v48, v49, v50
v_max_f32 v54, v54, v51
v_cvt_pk_bf16_f32 v52, v48, v49
v_cvt_pk_bf16_f32 v53, v50, v51
v_max_f32_dpp v54, v54, v54 row_ror:8 row_mask:0xf bank_mask:0xf
v_mov_b32 v55, v54
v_lshlrev_b32 v48, 16, v52
v_and_b32 v49, 0xffff0000, v52
v_permlane16_swap_b32 v54, v55
v_max_f32 v54, v54, v55
v_mov_b32 v55, v54
v_lshlrev_b32 v50, 16, v53
v_and_b32 v51, 0xffff0000, v53
v_permlane32_swap_b32 v54, v55
v_max_f32 v54, v54, v55
v_mul_f32 v48, 0x3db504f3, v48
v_mul_f32 v49, 0x3db504f3, v49
v_cvt_pk_bf16_f32 v54, v54, v54
v_mul_f32 v50, 0x3db504f3, v50
v_mul_f32 v51, 0x3db504f3, v51
v_and_b32 v54, 0xffff0000, v54
v_cvt_pk_bf16_f32 v52, v48, v49
v_mul_f32 v54, 0x3db504f3, v54
v_cvt_pk_bf16_f32 v53, v50, v51
v_cvt_pk_bf16_f32 v54, v54, v54
v_lshlrev_b32 v48, 16, v52
v_and_b32 v49, 0xffff0000, v52
v_and_b32 v54, 0xffff0000, v54
v_lshlrev_b32 v50, 16, v53
v_and_b32 v51, 0xffff0000, v53
v_sub_f32 v48, v48, v54
v_sub_f32 v49, v49, v54
v_sub_f32 v50, v50, v54
v_sub_f32 v51, v51, v54
v_mul_f32 v48, s50, v48
v_mul_f32 v49, s50, v49
v_mul_f32 v50, s50, v50
v_mul_f32 v51, s50, v51
v_exp_f32 v48, v48
v_exp_f32 v49, v49
v_exp_f32 v50, v50
v_exp_f32 v51, v51
v_mul_f32 v56, s50, v54
v_add_f32 v57, v48, v49
v_add_f32 v58, v50, v51
v_add_f32 v57, v57, v58
s_nop 1
v_add_f32_dpp v57, v57, v57 row_ror:8 row_mask:0xf bank_mask:0xf
v_mov_b32 v58, v57
s_nop 1
v_permlane16_swap_b32 v57, v58
v_add_f32 v57, v57, v58
v_mov_b32 v58, v57
s_nop 1
v_permlane32_swap_b32 v57, v58
v_add_f32 v57, v57, v58
ds_write_b64 v25, v[56:57] offset:256
s_waitcnt lgkmcnt(0)
s_barrier
ds_read_b128 v[32:35], v26 offset:256
ds_read_b128 v[36:39], v26 offset:272
s_waitcnt lgkmcnt(0)
v_max3_f32 v40, v32, v34, v36
v_max_f32 v40, v40, v38
v_sub_f32 v32, v32, v40
v_sub_f32 v34, v34, v40
v_sub_f32 v36, v36, v40
v_sub_f32 v38, v38, v40
v_sub_f32 v56, v56, v40
v_exp_f32 v32, v32
v_exp_f32 v34, v34
v_exp_f32 v36, v36
v_exp_f32 v38, v38
v_exp_f32 v56, v56
v_mul_f32 v41, v32, v33
v_fmac_f32 v41, v34, v35
v_fmac_f32 v41, v36, v37
v_fmac_f32 v41, v38, v39
v_rcp_f32 v42, v41
v_log_f32 v43, v41
v_mul_f32 v56, v56, v42
v_add_f32 v30, v40, v43
v_mul_f32 v48, v48, v56
v_mul_f32 v49, v49, v56
v_mul_f32 v50, v50, v56
v_mul_f32 v51, v51, v56
v_cvt_pk_bf16_f32 v28, v48, v49
v_cvt_pk_bf16_f32 v29, v50, v51
buffer_store_dwordx4 v[28:31], v14, s[40:43], s60 offen sc1
s_barrier
s_cmp_lg_u32 s58, 4
s_cbranch_scc1 sk_60
s_setprio 2
buffer_load_dwordx4 v[96:99], v13, s[36:39], s54 offen nt
s_add_u32 s50, s54, 0x3000
buffer_load_dwordx4 v[100:103], v13, s[36:39], s50 offen nt
s_add_u32 s50, s54, 0x6000
buffer_load_dwordx4 v[104:107], v13, s[36:39], s50 offen nt
s_add_u32 s50, s54, 0x9000
buffer_load_dwordx4 v[108:111], v13, s[36:39], s50 offen nt
s_add_u32 s50, s54, 0xc000
buffer_load_dwordx4 v[112:115], v13, s[36:39], s50 offen nt
s_add_u32 s50, s54, 0xf000
buffer_load_dwordx4 v[116:119], v13, s[36:39], s50 offen nt
s_add_u32 s50, s54, 0x12000
buffer_load_dwordx4 v[120:123], v13, s[36:39], s50 offen nt
s_add_u32 s50, s54, 0x15000
buffer_load_dwordx4 v[124:127], v13, s[36:39], s50 offen nt
s_add_u32 s50, s54, 0x60000
buffer_load_dwordx4 v[160:163], v13, s[36:39], s50 offen nt
s_add_u32 s50, s54, 0x63000
buffer_load_dwordx4 v[164:167], v13, s[36:39], s50 offen nt
s_add_u32 s50, s54, 0x66000
buffer_load_dwordx4 v[168:171], v13, s[36:39], s50 offen nt
s_add_u32 s50, s54, 0x69000
buffer_load_dwordx4 v[172:175], v13, s[36:39], s50 offen nt
s_add_u32 s50, s54, 0x6c000
buffer_load_dwordx4 v[176:179], v13, s[36:39], s50 offen nt
s_add_u32 s50, s54, 0x6f000
buffer_load_dwordx4 v[180:183], v13, s[36:39], s50 offen nt
s_add_u32 s50, s54, 0x72000
buffer_load_dwordx4 v[184:187], v13, s[36:39], s50 offen nt
s_add_u32 s50, s54, 0x75000
buffer_load_dwordx4 v[188:191], v13, s[36:39], s50 offen nt
s_setprio 0
sk_60:
s_barrier
s_cmp_ge_u32 s49, 28
s_cbranch_scc1 L_p_lead
buffer_load_dwordx4 v[64:67], v12, s[32:35], s57 offen nt
s_add_u32 s50, s57, 0x1c00
buffer_load_dwordx4 v[68:71], v12, s[32:35], s50 offen nt
s_add_u32 s50, s57, 0x3800
buffer_load_dwordx4 v[72:75], v12, s[32:35], s50 offen nt
s_add_u32 s50, s57, 0x5400
buffer_load_dwordx4 v[76:79], v12, s[32:35], s50 offen nt
s_add_u32 s50, s57, 0x7000
buffer_load_dwordx4 v[80:83], v12, s[32:35], s50 offen nt
s_add_u32 s50, s57, 0x8c00
buffer_load_dwordx4 v[84:87], v12, s[32:35], s50 offen nt
s_add_u32 s50, s57, 0xa800
buffer_load_dwordx4 v[88:91], v12, s[32:35], s50 offen nt
s_add_u32 s50, s57, 0xc400
buffer_load_dwordx4 v[92:95], v12, s[32:35], s50 offen nt
s_barrier
s_barrier
L_p_w1:
s_barrier
s_cmp_lg_u32 s58, 4
s_cbranch_scc1 sk_61
s_waitcnt vmcnt(16)
v_perm_b32 v192, v100, v96, s67
v_perm_b32 v196, v100, v96, s68
v_perm_b32 v200, v101, v97, s67
v_perm_b32 v204, v101, v97, s68
v_perm_b32 v208, v102, v98, s67
v_perm_b32 v212, v102, v98, s68
v_perm_b32 v216, v103, v99, s67
v_perm_b32 v220, v103, v99, s68
v_perm_b32 v193, v108, v104, s67
v_perm_b32 v197, v108, v104, s68
v_perm_b32 v201, v109, v105, s67
v_perm_b32 v205, v109, v105, s68
v_perm_b32 v209, v110, v106, s67
v_perm_b32 v213, v110, v106, s68
v_perm_b32 v217, v111, v107, s67
v_perm_b32 v221, v111, v107, s68
v_perm_b32 v194, v116, v112, s67
v_perm_b32 v198, v116, v112, s68
v_perm_b32 v202, v117, v113, s67
v_perm_b32 v206, v117, v113, s68
v_perm_b32 v210, v118, v114, s67
v_perm_b32 v214, v118, v114, s68
v_perm_b32 v218, v119, v115, s67
v_perm_b32 v222, v119, v115, s68
v_perm_b32 v195, v124, v120, s67
v_perm_b32 v199, v124, v120, s68
v_perm_b32 v203, v125, v121, s67
v_perm_b32 v207, v125, v121, s68
v_perm_b32 v211, v126, v122, s67
v_perm_b32 v215, v126, v122, s68
v_perm_b32 v219, v127, v123, s67
v_perm_b32 v223, v127, v123, s68
v_mfma_f32_16x16x32_bf16 v[32:35], v[224:227], v[192:195], 0
v_mfma_f32_16x16x32_bf16 v[36:39], v[224:227], v[196:199], 0
v_mfma_f32_16x16x32_bf16 v[40:43], v[224:227], v[200:203], 0
v_mfma_f32_16x16x32_bf16 v[44:47], v[224:227], v[204:207], 0
v_mfma_f32_16x16x32_bf16 v[48:51], v[224:227], v[208:211], 0
v_mfma_f32_16x16x32_bf16 v[52:55], v[224:227], v[212:215], 0
v_mfma_f32_16x16x32_bf16 v[56:59], v[224:227], v[216:219], 0
v_mfma_f32_16x16x32_bf16 v[60:63], v[224:227], v[220:223], 0
s_waitcnt vmcnt(8)
v_perm_b32 v96, v164, v160, s67
v_perm_b32 v100, v164, v160, s68
v_perm_b32 v104, v165, v161, s67
v_perm_b32 v108, v165, v161, s68
v_perm_b32 v112, v166, v162, s67
v_perm_b32 v116, v166, v162, s68
v_perm_b32 v120, v167, v163, s67
v_perm_b32 v124, v167, v163, s68
v_perm_b32 v97, v172, v168, s67
v_perm_b32 v101, v172, v168, s68
v_perm_b32 v105, v173, v169, s67
v_perm_b32 v109, v173, v169, s68
v_perm_b32 v113, v174, v170, s67
v_perm_b32 v117, v174, v170, s68
v_perm_b32 v121, v175, v171, s67
v_perm_b32 v125, v175, v171, s68
v_perm_b32 v98, v180, v176, s67
v_perm_b32 v102, v180, v176, s68
v_perm_b32 v106, v181, v177, s67
v_perm_b32 v110, v181, v177, s68
v_perm_b32 v114, v182, v178, s67
v_perm_b32 v118, v182, v178, s68
v_perm_b32 v122, v183, v179, s67
v_perm_b32 v126, v183, v179, s68
v_perm_b32 v99, v188, v184, s67
v_perm_b32 v103, v188, v184, s68
v_perm_b32 v107, v189, v185, s67
v_perm_b32 v111, v189, v185, s68
v_perm_b32 v115, v190, v186, s67
v_perm_b32 v119, v190, v186, s68
v_perm_b32 v123, v191, v187, s67
v_perm_b32 v127, v191, v187, s68
v_mfma_f32_16x16x32_bf16 v[32:35], v[228:231], v[96:99], v[32:35]
v_mfma_f32_16x16x32_bf16 v[36:39], v[228:231], v[100:103], v[36:39]
v_mfma_f32_16x16x32_bf16 v[40:43], v[228:231], v[104:107], v[40:43]
v_mfma_f32_16x16x32_bf16 v[44:47], v[228:231], v[108:111], v[44:47]
v_mfma_f32_16x16x32_bf16 v[48:51], v[228:231], v[112:115], v[48:51]
v_mfma_f32_16x16x32_bf16 v[52:55], v[228:231], v[116:119], v[52:55]
v_mfma_f32_16x16x32_bf16 v[56:59], v[228:231], v[120:123], v[56:59]
v_mfma_f32_16x16x32_bf16 v[60:63], v[228:231], v[124:127], v[60:63]
v_lshlrev_b32 v30, 3, v3
v_lshrrev_b32 v30, v30, s31
v_bfe_u32 v31, v30, 4, 4
v_and_b32 v30, 15, v30
s_nop 0
v_mov_b32_dpp v28, v32 quad_perm:[0,1,2,3] row_mask:0x1 bank_mask:0xf
v_mov_b32_dpp v29, v36 quad_perm:[0,1,2,3] row_mask:0x1 bank_mask:0xf
v_mov_b32_dpp v28, v40 quad_perm:[0,1,2,3] row_mask:0x2 bank_mask:0xf
v_mov_b32_dpp v29, v44 quad_perm:[0,1,2,3] row_mask:0x2 bank_mask:0xf
v_mov_b32_dpp v28, v48 quad_perm:[0,1,2,3] row_mask:0x4 bank_mask:0xf
v_mov_b32_dpp v29, v52 quad_perm:[0,1,2,3] row_mask:0x4 bank_mask:0xf
v_mov_b32_dpp v28, v56 quad_perm:[0,1,2,3] row_mask:0x8 bank_mask:0xf
v_mov_b32_dpp v29, v60 quad_perm:[0,1,2,3] row_mask:0x8 bank_mask:0xf
v_add_u32 v28, 8, v28
v_and_or_b32 v28, v28, s69, v30
v_add_u32 v29, 8, v29
v_and_or_b32 v29, v29, s69, v31
buffer_store_dwordx2 v[28:29], v5, s[40:43], s56 offen sc1
sk_61:
s_xor_b32 s61, s49, 0
s_lshl_b32 s61, s61, 2
s_add_u32 s61, s61, s48
s_lshl_b32 s61, s61, 9
s_add_u32 s61, s61, 0x60000
s_lshl_b32 s51, s59, 8
s_add_u32 s51, s51, 0x38000
s_lshl_b32 s60, s59, 7
s_add_u32 s60, s60, 0x3b000
s_lshl_b32 s62, s48, 8
s_add_u32 s62, s62, 0x37000
v_and_b32 v14, 31, v1
v_lshlrev_b32 v22, 3, v14
v_lshlrev_b32 v15, 2, v14
s_lshl_b32 s50, s3, 6
s_add_u32 s50, s50, 0x200
v_lshl_add_u32 v14, v14, 1, s50
v_mov_b32 v23, v2
s_mov_b32 s64, 0
buffer_load_dwordx2 v[20:21], v22, s[40:43], s51 offen offset:0 sc1
s_waitcnt vmcnt(7)
v_perm_b32 v128, v68, v64, s67
v_perm_b32 v132, v68, v64, s68
v_perm_b32 v136, v69, v65, s67
v_perm_b32 v140, v69, v65, s68
v_perm_b32 v144, v70, v66, s67
v_perm_b32 v148, v70, v66, s68
v_perm_b32 v152, v71, v67, s67
v_perm_b32 v156, v71, v67, s68
s_waitcnt vmcnt(5)
v_perm_b32 v129, v76, v72, s67
v_perm_b32 v133, v76, v72, s68
v_perm_b32 v137, v77, v73, s67
v_perm_b32 v141, v77, v73, s68
v_perm_b32 v145, v78, v74, s67
v_perm_b32 v149, v78, v74, s68
v_perm_b32 v153, v79, v75, s67
v_perm_b32 v157, v79, v75, s68
s_waitcnt vmcnt(3)
v_perm_b32 v130, v84, v80, s67
v_perm_b32 v134, v84, v80, s68
v_perm_b32 v138, v85, v81, s67
v_perm_b32 v142, v85, v81, s68
v_perm_b32 v146, v86, v82, s67
v_perm_b32 v150, v86, v82, s68
v_perm_b32 v154, v87, v83, s67
v_perm_b32 v158, v87, v83, s68
s_waitcnt vmcnt(1)
v_perm_b32 v131, v92, v88, s67
v_perm_b32 v135, v92, v88, s68
v_perm_b32 v139, v93, v89, s67
v_perm_b32 v143, v93, v89, s68
v_perm_b32 v147, v94, v90, s67
v_perm_b32 v151, v94, v90, s68
v_perm_b32 v155, v95, v91, s67
v_perm_b32 v159, v95, v91, s68
s_waitcnt vmcnt(0)
s_branch pchk_64
poll_62:
buffer_load_dwordx2 v[20:21], v22, s[40:43], s51 offen offset:0 sc1
s_waitcnt vmcnt(0)
pchk_64:
v_cmp_ne_u32 vcc, s31, v21
s_cbranch_vccz pdone_63
s_add_u32 s64, s64, 1
s_cmp_lt_u32 s64, 1000000
s_cbranch_scc1 poll_62
pdone_63:
s_mov_b64 exec, 0xffffffff
v_lshlrev_b32 v21, 16, v20
v_and_b32 v20, 0xffff0000, v20
s_mov_b32 s64, 0
poll_65:
buffer_load_dword v24, v15, s[40:43], s60 offen offset:0 sc1
buffer_load_dwordx4 v[32:35], v23, s[40:43], s62 offen offset:0 sc1
s_waitcnt vmcnt(0)
pchk_67:
v_xor_b32 v24, v11, v24
v_xor_b32 v35, s31, v35
v_and_or_b32 v28, v24, 15, v35
v_cmp_ne_u32 vcc, 0, v28
s_cbranch_vccz pdone_66
s_add_u32 s64, s64, 1
s_cmp_lt_u32 s64, 1000000
s_cbranch_scc1 poll_65
pdone_66:
v_fmamk_f32 v36, v32, 0x42800000, v33
s_nop 1
v_add_f32_dpp v36, v36, v36 quad_perm:[1,0,3,2] row_mask:0xf bank_mask:0xf
s_nop 1
v_add_f32_dpp v36, v36, v36 quad_perm:[2,3,0,1] row_mask:0xf bank_mask:0xf
s_nop 1
v_add_f32_dpp v36, v36, v36 row_half_mirror row_mask:0xf bank_mask:0xf
s_nop 1
v_add_f32_dpp v36, v36, v36 row_mirror row_mask:0xf bank_mask:0xf
v_mul_f32 v25, 0x3a800000, v36
v_sub_f32 v37, v25, v32
v_mul_f32 v38, 0x42800000, v37
v_fma_f32 v38, -2.0, v33, v38
v_fmac_f32 v34, v37, v38
v_cvt_pk_bf16_f32 v25, v25, v25
v_and_b32 v25, 0xffff0000, v25
v_add_f32_dpp v34, v34, v34 quad_perm:[1,0,3,2] row_mask:0xf bank_mask:0xf
v_sub_f32 v24, v24, v25
v_cvt_pk_bf16_f32 v24, v24, v24
v_add_f32_dpp v34, v34, v34 quad_perm:[2,3,0,1] row_mask:0xf bank_mask:0xf
v_and_b32 v24, 0xffff0000, v24
s_nop 0
v_add_f32_dpp v34, v34, v34 row_half_mirror row_mask:0xf bank_mask:0xf
s_nop 1
v_add_f32_dpp v34, v34, v34 row_mirror row_mask:0xf bank_mask:0xf
v_mul_f32 v34, 0x3a800000, v34
v_max_f32 v34, 0, v34
v_cvt_pk_bf16_f32 v34, v34, v34
v_and_b32 v34, 0xffff0000, v34
v_add_f32 v34, 0x3727c5ac, v34
v_cvt_pk_bf16_f32 v34, v34, v34
v_and_b32 v34, 0xffff0000, v34
v_sqrt_f32 v34, v34
s_nop 0
v_cvt_pk_bf16_f32 v34, v34, v34
v_and_b32 v34, 0xffff0000, v34
v_rcp_f32 v34, v34
s_nop 0
v_mul_f32 v24, v24, v34
v_cvt_pk_bf16_f32 v24, v24, v24
v_and_b32 v24, 0xffff0000, v24
v_mul_f32 v24, v24, v21
v_cvt_pk_bf16_f32 v24, v24, v24
v_and_b32 v24, 0xffff0000, v24
v_add_f32 v24, v24, v20
v_cvt_pk_bf16_f32 v24, v24, v24
ds_write_b16 v14, v24
s_mov_b64 exec, -1
ds_read_b128 v[16:19], v7
s_waitcnt lgkmcnt(0)
v_mfma_f32_16x16x32_bf16 v[32:35], v[16:19], v[128:131], 0
v_mfma_f32_16x16x32_bf16 v[36:39], v[16:19], v[132:135], 0
v_mfma_f32_16x16x32_bf16 v[40:43], v[16:19], v[136:139], 0
v_mfma_f32_16x16x32_bf16 v[44:47], v[16:19], v[140:143], 0
v_mfma_f32_16x16x32_bf16 v[48:51], v[16:19], v[144:147], 0
v_mfma_f32_16x16x32_bf16 v[52:55], v[16:19], v[148:151], 0
v_mfma_f32_16x16x32_bf16 v[56:59], v[16:19], v[152:155], 0
v_mfma_f32_16x16x32_bf16 v[60:63], v[16:19], v[156:159], 0
s_nop 0
v_mov_b32_dpp v28, v32 quad_perm:[0,1,2,3] row_mask:0x1 bank_mask:0xf
v_mov_b32_dpp v29, v36 quad_perm:[0,1,2,3] row_mask:0x1 bank_mask:0xf
v_mov_b32_dpp v28, v40 quad_perm:[0,1,2,3] row_mask:0x2 bank_mask:0xf
v_mov_b32_dpp v29, v44 quad_perm:[0,1,2,3] row_mask:0x2 bank_mask:0xf
v_mov_b32_dpp v28, v48 quad_perm:[0,1,2,3] row_mask:0x4 bank_mask:0xf
v_mov_b32_dpp v29, v52 quad_perm:[0,1,2,3] row_mask:0x4 bank_mask:0xf
v_mov_b32_dpp v28, v56 quad_perm:[0,1,2,3] row_mask:0x8 bank_mask:0xf
v_mov_b32_dpp v29, v60 quad_perm:[0,1,2,3] row_mask:0x8 bank_mask:0xf
ds_write_b64 v8, v[28:29]
s_lshr_b32 s50, s3, 1
s_waitcnt lgkmcnt(0)
s_barrier
s_cmp_lg_u32 s50, 0
s_cbranch_scc1 sk_68
ds_read2st64_b32 v[48:49], v6 offset0:4 offset1:6
ds_read2st64_b32 v[50:51], v6 offset0:8 offset1:10
ds_read2st64_b32 v[52:53], v6 offset0:12 offset1:14
ds_read2st64_b32 v[54:55], v6 offset0:16 offset1:18
s_waitcnt lgkmcnt(2)
v_add_f32 v48, v48, v49
v_add_f32 v50, v50, v51
s_waitcnt lgkmcnt(0)
v_add_f32 v52, v52, v53
v_add_f32 v54, v54, v55
v_add_f32 v48, v48, v50
v_add_f32 v52, v52, v54
v_add_f32 v48, v48, v52
v_add_u32 v48, 8, v48
v_and_or_b32 v48, v48, s69, v11
buffer_store_dword v48, v6, s[40:43], s61 offen sc1
sk_68:
s_branch L_exit
L_p_cs:
s_cmp_lg_u32 s3, 1
s_cbranch_scc1 L_exit
s_lshl_b32 s63, s48, 2
s_add_u32 s63, s63, s49
s_sub_u32 s63, s63, 28
s_and_b32 s63, s63, 15
v_lshrrev_b32 v22, 2, v2
v_add_u32 v22, v22, v3
v_lshlrev_b32 v23, 1, v22
v_lshlrev_b32 v25, 3, v22
v_lshlrev_b32 v22, 2, v22
v_lshl_add_u32 v14, v3, 9, v2
v_and_b32 v15, 1, v3
v_lshl_add_u32 v15, v15, 9, v2
s_lshr_b32 s51, s63, 1
s_lshl_b32 s51, s51, 12
s_and_b32 s50, s63, 1
s_lshl_b32 s50, s50, 8
s_add_u32 s51, s51, s50
s_add_u32 s51, s51, 0xc0000
s_add_u32 s52, s51, 0x8000
s_mov_b32 s64, 0
poll_69:
buffer_load_dwordx4 v[32:35], v14, s[40:43], s51 offen offset:0 sc1
buffer_load_dwordx4 v[36:39], v14, s[40:43], s51 offen offset:2048 sc1
buffer_load_dwordx4 v[40:43], v14, s[40:43], s52 offen offset:0 sc1
buffer_load_dwordx4 v[44:47], v14, s[40:43], s52 offen offset:2048 sc1
s_waitcnt vmcnt(0)
pchk_71:
v_xor_b32 v32, v248, v32
v_xor_b32 v33, v249, v33
v_xor_b32 v34, v250, v34
v_xor_b32 v35, v251, v35
v_xor_b32 v36, v248, v36
v_xor_b32 v37, v249, v37
v_xor_b32 v38, v250, v38
v_xor_b32 v39, v251, v39
v_xor_b32 v40, v248, v40
v_xor_b32 v41, v249, v41
v_xor_b32 v42, v250, v42
v_xor_b32 v43, v251, v43
v_xor_b32 v44, v248, v44
v_xor_b32 v45, v249, v45
v_xor_b32 v46, v250, v46
v_xor_b32 v47, v251, v47
v_or3_b32 v28, v32, v33, v34
v_or3_b32 v28, v28, v35, v36
v_or3_b32 v28, v28, v37, v38
v_or3_b32 v28, v28, v39, v40
v_or3_b32 v28, v28, v41, v42
v_or3_b32 v28, v28, v43, v44
v_or3_b32 v28, v28, v45, v46
v_or_b32 v28, v28, v47
v_and_b32 v28, 15, v28
v_cmp_ne_u32 vcc, 0, v28
s_cbranch_vccz pdone_70
s_sleep 3
s_add_u32 s64, s64, 1
s_cmp_lt_u32 s64, 1000000
s_cbranch_scc1 poll_69
pdone_70:
v_add_f32 v32, v32, v36
v_add_f32 v33, v33, v37
v_add_f32 v34, v34, v38
v_add_f32 v35, v35, v39
v_add_f32 v36, v40, v44
v_add_f32 v37, v41, v45
v_add_f32 v38, v42, v46
v_add_f32 v39, v43, v47
v_permlane16_swap_b32 v32, v33
v_permlane16_swap_b32 v34, v35
v_permlane16_swap_b32 v36, v37
v_permlane16_swap_b32 v38, v39
v_add_f32 v32, v32, v33
v_add_f32 v34, v34, v35
v_add_f32 v36, v36, v37
v_add_f32 v38, v38, v39
s_nop 0
v_permlane32_swap_b32 v32, v34
v_permlane32_swap_b32 v36, v38
v_add_f32 v32, v32, v34
v_add_f32 v36, v36, v38
v_cvt_pk_bf16_f32 v36, v36, v36
v_and_b32 v36, 0xffff0000, v36
v_add_f32 v36, 1.0, v36
v_mov_b32 v33, s31
v_cvt_pk_bf16_f32 v32, v36, v32
s_lshl_b32 s51, s63, 9
s_add_u32 s51, s51, 0x38000
buffer_store_dwordx2 v[32:33], v25, s[40:43], s51 offen
s_cmp_eq_u32 s65, 1
s_cbranch_scc1 sk_72
buffer_store_dwordx2 v[32:33], v25, s[40:43], s51 offen sc1
sk_72:
s_branch L_exit
L_p_lead:
s_lshl_b32 s63, s48, 2
s_add_u32 s63, s63, s49
s_sub_u32 s63, s63, 28
s_and_b32 s63, s63, 15
v_lshrrev_b32 v22, 2, v2
v_add_u32 v22, v22, v3
v_lshlrev_b32 v23, 1, v22
v_lshlrev_b32 v25, 3, v22
v_lshlrev_b32 v22, 2, v22
v_lshl_add_u32 v14, v3, 9, v2
v_and_b32 v15, 1, v3
v_lshl_add_u32 v15, v15, 9, v2
s_sub_u32 s63, s49, 28
s_lshl_b32 s63, s63, 2
s_add_u32 s63, s63, s3
s_sub_u32 s63, s63, 4
v_and_b32 v26, 1, v1
v_lshl_add_u32 v26, v26, 2, v3
v_lshlrev_b32 v26, 2, v26
v_bfe_u32 v26, s31, v26, 4
s_mov_b32 s44, s4
s_mov_b32 s45, s5
s_mov_b32 s46, 0x800
s_mov_b32 s47, 0x20000
s_lshl_b32 s50, s63, 7
buffer_load_ushort v27, v23, s[44:47], s50 offen
v_and_b32 v224, 31, v1
v_lshlrev_b32 v224, 3, v224
s_and_b32 s50, s2, 7
s_lshl_b32 s50, s50, 8
s_add_u32 s50, s50, 0x3a000
buffer_load_dwordx2 v[226:227], v224, s[40:43], s50 offen offset:0 sc1
s_lshr_b32 s51, s63, 1
s_lshl_b32 s51, s51, 13
s_and_b32 s50, s63, 1
s_lshl_b32 s50, s50, 8
s_add_u32 s51, s51, s50
s_mov_b32 s4, s51
s_add_u32 s4, s4, 0x40000
s_add_u32 s5, s4, 4096
s_add_u32 s47, s5, 0x2000
s_add_u32 s8, s51, 0x80000
s_add_u32 s9, s8, 4096
s_lshl_b32 s52, s63, 8
s_add_u32 s55, s52, 0x36000
s_add_u32 s52, s52, 0x3b000
s_lshl_b32 s53, s48, 4
s_add_u32 s53, s53, s63
s_lshl_b32 s53, s53, 4
s_add_u32 s53, s53, 0x37000
buffer_load_dword v48, v9, s[40:43], s52 offen offset:0 sc1
buffer_load_dword v49, v4, s[40:43], s53 offen offset:0 sc1
s_barrier
s_mov_b32 s64, 0
poll_73:
buffer_load_dwordx4 v[160:163], v14, s[40:43], s8 offen offset:0 sc1
buffer_load_dwordx4 v[164:167], v14, s[40:43], s8 offen offset:2048 sc1
buffer_load_dwordx4 v[168:171], v14, s[40:43], s9 offen offset:0 sc1
buffer_load_dwordx4 v[172:175], v14, s[40:43], s9 offen offset:2048 sc1
s_waitcnt vmcnt(0)
pchk_75:
v_xor_b32 v160, v248, v160
v_xor_b32 v161, v249, v161
v_xor_b32 v162, v250, v162
v_xor_b32 v163, v251, v163
v_xor_b32 v164, v248, v164
v_xor_b32 v165, v249, v165
v_xor_b32 v166, v250, v166
v_xor_b32 v167, v251, v167
v_xor_b32 v168, v248, v168
v_xor_b32 v169, v249, v169
v_xor_b32 v170, v250, v170
v_xor_b32 v171, v251, v171
v_xor_b32 v172, v248, v172
v_xor_b32 v173, v249, v173
v_xor_b32 v174, v250, v174
v_xor_b32 v175, v251, v175
v_or3_b32 v28, v160, v161, v162
v_or3_b32 v28, v28, v163, v164
v_or3_b32 v28, v28, v165, v166
v_or3_b32 v28, v28, v167, v168
v_or3_b32 v28, v28, v169, v170
v_or3_b32 v28, v28, v171, v172
v_or3_b32 v28, v28, v173, v174
v_or_b32 v28, v28, v175
v_and_b32 v28, 15, v28
v_cmp_ne_u32 vcc, 0, v28
s_cbranch_vccz pdone_74
s_add_u32 s64, s64, 1
s_cmp_lt_u32 s64, 1000000
s_cbranch_scc1 poll_73
pdone_74:
v_add_f32 v160, v160, v164
v_add_f32 v161, v161, v165
v_add_f32 v162, v162, v166
v_add_f32 v163, v163, v167
v_add_f32 v168, v168, v172
v_add_f32 v169, v169, v173
v_add_f32 v170, v170, v174
v_add_f32 v171, v171, v175
v_add_f32 v160, v160, v168
v_add_f32 v161, v161, v169
v_add_f32 v162, v162, v170
v_add_f32 v163, v163, v171
s_nop 0
v_permlane16_swap_b32 v160, v161
v_permlane16_swap_b32 v162, v163
v_add_f32 v160, v160, v161
v_add_f32 v162, v162, v163
s_nop 1
v_permlane32_swap_b32 v160, v162
v_add_f32 v160, v160, v162
v_cvt_pk_bf16_f32 v160, v160, v160
v_and_b32 v160, 0xffff0000, v160
v_xor_b32 v226, s66, v226
v_xor_b32 v227, s31, v227
v_or_b32 v226, v226, v227
v_cmp_ne_u32 vcc, 0, v226
s_cmp_eq_u64 vcc, 0
s_cselect_b32 s65, 1, 0
v_lshlrev_b32 v27, 16, v27
v_mov_b32 v51, s31
s_lshr_b32 s56, s63, 2
s_mov_b32 s64, 0
poll_76:
buffer_load_dwordx4 v[32:35], v14, s[40:43], s4 offen offset:0 sc1
buffer_load_dwordx4 v[36:39], v14, s[40:43], s4 offen offset:2048 sc1
buffer_load_dwordx4 v[40:43], v14, s[40:43], s5 offen offset:0 sc1
buffer_load_dwordx4 v[44:47], v14, s[40:43], s5 offen offset:2048 sc1
s_waitcnt vmcnt(0)
pchk_78:
v_xor_b32 v32, v248, v32
v_xor_b32 v33, v249, v33
v_xor_b32 v34, v250, v34
v_xor_b32 v35, v251, v35
v_xor_b32 v36, v248, v36
v_xor_b32 v37, v249, v37
v_xor_b32 v38, v250, v38
v_xor_b32 v39, v251, v39
v_xor_b32 v40, v248, v40
v_xor_b32 v41, v249, v41
v_xor_b32 v42, v250, v42
v_xor_b32 v43, v251, v43
v_xor_b32 v44, v248, v44
v_xor_b32 v45, v249, v45
v_xor_b32 v46, v250, v46
v_xor_b32 v47, v251, v47
v_or3_b32 v28, v32, v33, v34
v_or3_b32 v28, v28, v35, v36
v_or3_b32 v28, v28, v37, v38
v_or3_b32 v28, v28, v39, v40
v_or3_b32 v28, v28, v41, v42
v_or3_b32 v28, v28, v43, v44
v_or3_b32 v28, v28, v45, v46
v_or_b32 v28, v28, v47
v_and_b32 v28, 15, v28
v_cmp_ne_u32 vcc, 0, v28
s_cbranch_vccz pdone_77
s_add_u32 s64, s64, 1
s_cmp_lt_u32 s64, 1000000
s_cbranch_scc1 poll_76
pdone_77:
v_add_f32 v32, v32, v36
v_add_f32 v33, v33, v37
v_add_f32 v34, v34, v38
v_add_f32 v35, v35, v39
v_add_f32 v40, v40, v44
v_add_f32 v41, v41, v45
v_add_f32 v42, v42, v46
v_add_f32 v43, v43, v47
v_add_f32 v32, v32, v40
v_add_f32 v33, v33, v41
v_add_f32 v34, v34, v42
v_add_f32 v35, v35, v43
s_nop 0
v_permlane16_swap_b32 v32, v33
v_permlane16_swap_b32 v34, v35
v_add_f32 v32, v32, v33
v_add_f32 v34, v34, v35
s_nop 1
v_permlane32_swap_b32 v32, v34
v_add_f32 v32, v32, v34
v_cvt_pk_bf16_f32 v32, v32, v32
v_and_b32 v32, 0xffff0000, v32
v_mul_f32 v32, v32, v160
v_cvt_pk_bf16_f32 v32, v32, v32
v_and_b32 v32, 0xffff0000, v32
v_add_f32 v27, v27, v32
v_cvt_pk_bf16_f32 v27, v27, v27
v_and_b32 v27, 0xffff0000, v27
v_or_b32 v33, v27, v26
v_readfirstlane_b32 s54, v27
s_cmp_lg_u32 s56, s48
s_cbranch_scc1 sk_79
s_cmp_eq_u32 s65, 0
s_cbranch_scc1 sk_80
buffer_store_dword v33, v22, s[40:43], s52 offen
s_branch sx_81
sk_80:
buffer_store_dword v33, v22, s[40:43], s52 offen sc1
sx_81:
sk_79:
v_subrev_f32 v34, s54, v27
v_mul_f32 v35, v34, v34
v_mov_b32 v48, s54
s_nop 0
v_permlane16_swap_b32 v34, v35
v_add_f32 v34, v34, v35
v_mov_b32 v35, v34
s_nop 1
v_permlane32_swap_b32 v34, v35
v_add_f32 v34, v34, v35
s_nop 1
v_add_f32_dpp v34, v34, v34 quad_perm:[1,0,3,2] row_mask:0xf bank_mask:0xf
s_nop 1
v_add_f32_dpp v34, v34, v34 quad_perm:[2,3,0,1] row_mask:0xf bank_mask:0xf
s_nop 1
v_add_f32_dpp v34, v34, v34 row_half_mirror row_mask:0xf bank_mask:0xf
s_nop 1
v_add_f32_dpp v49, v34, v34 row_mirror row_mask:0xf bank_mask:0xf
v_add_f32_dpp v50, v34, v34 row_mirror row_mask:0xf bank_mask:0xf
s_mov_b64 exec, 0xffffffff
s_nop 0
v_permlane16_swap_b32 v49, v50
s_mov_b64 exec, 1
s_cmp_eq_u32 s65, 0
s_cbranch_scc1 sk_82
buffer_store_dwordx4 v[48:51], v2, s[40:43], s53 offen
s_branch sx_83
sk_82:
buffer_store_dwordx4 v[48:51], v2, s[40:43], s53 offen sc1
sx_83:
s_mov_b64 exec, -1
s_cmp_lg_u32 s56, s48
s_cbranch_scc1 L_exit
buffer_store_dword v33, v22, s[40:43], s55 offen sc1
s_branch L_exit
L_exit:
L_end:
s_endpgm
.section .rodata,"a"
.p2align 6
.amdhsa_kernel adaLN_cond__sliding_block_cached__dense_activation_silu__decode_kernel
  .amdhsa_next_free_vgpr 256
  .amdhsa_next_free_sgpr 102
  .amdhsa_accum_offset 256
  .amdhsa_group_segment_fixed_size 0
  .amdhsa_kernarg_size 104
  .amdhsa_user_sgpr_count 2
  .amdhsa_user_sgpr_kernarg_segment_ptr 1
  .amdhsa_system_sgpr_workgroup_id_x 1
  .amdhsa_float_denorm_mode_32 3
.end_amdhsa_kernel
```
